```python
import torch

def _softmax(x, axis=-1):
    return torch.softmax(x, dim=axis)
def _gelu(x):
    return torch.nn.functional.gelu(x, approximate="tanh")
def _silu(x):
    return torch.nn.functional.silu(x)
def _sigmoid(x):
    return torch.sigmoid(x)
def _layernorm(x, axis=-1, eps=1e-5):
    m = x.mean(dim=axis, keepdim=True)
    v = x.var(dim=axis, keepdim=True, unbiased=False)
    return (x - m) / torch.sqrt(v + eps)
def _scatter_add(tgt, idx, src, axis=0):
    return tgt.clone().index_add_(axis, idx, src)
def _segment_sum(src, seg, n):
    out = torch.zeros((n,) + src.shape[1:], dtype=src.dtype)
    return out.index_add_(0, seg, src)
def _pad(x, pw):
    flat = tuple(v for pair in reversed(pw) for v in pair)
    return torch.nn.functional.pad(x, flat)

kernel_name = 'concat_heads__spectral_gfnet__ssm_conv_s4__prompt'

def setup_inputs():

    _w = (lambda a: (lambda t: t.to(torch.bfloat16) if t.is_floating_point() else t)(torch.as_tensor(a)))
    def _A_setup():
        B, S, D = 1, 2048, 1024
        Df = D // 2 + 1
        return {
            "x": _w((lambda *s: torch.randn(*s, dtype=torch.bfloat16) * 0.05)(B, S, D)),
            "w_r": _w((lambda *s: torch.randn(*s, dtype=torch.bfloat16) * 1.6)(S, Df) * 0.02),
            "w_i": _w((lambda *s: torch.randn(*s, dtype=torch.bfloat16) * 1.6)(S, Df) * 0.02),
        }
    _A_in = _A_setup()

    def _B_setup():
        B, L, D, N = 1, 2048, 1024, 128
        A_re = -(lambda _x: torch.exp(torch.as_tensor(_x)))((lambda *s: torch.randn(*s, dtype=torch.bfloat16) * 3.2)(D, N))
        A_im = torch.pi * (lambda *s: torch.randn(*s, dtype=torch.bfloat16) * 0.05)(D, N)
        B_re = (lambda *s: torch.randn(*s, dtype=torch.bfloat16) * 0.1)(D, N)
        B_im = (lambda *s: torch.randn(*s, dtype=torch.bfloat16) * 0.1)(D, N)
        C_re = (lambda *s: torch.randn(*s, dtype=torch.bfloat16) * 0.1)(D, N)
        C_im = (lambda *s: torch.randn(*s, dtype=torch.bfloat16) * 0.1)(D, N)
        log_dt = (lambda *s: torch.randn(*s, dtype=torch.bfloat16) * 0.05)(D) * 0.5 - 4.0
        Dskip = (lambda *s: torch.randn(*s, dtype=torch.bfloat16) * 0.05)(D)
        return {
            "u": _w((lambda *s: torch.randn(*s, dtype=torch.bfloat16) * 0.05)(B, L, D)),
            "A_re": _w(A_re),
            "A_im": _w(A_im),
            "B_re": _w(B_re),
            "B_im": _w(B_im),
            "C_re": _w(C_re),
            "C_im": _w(C_im),
            "log_dt": _w(log_dt),
            "Dskip": _w(Dskip),
        }
    _B_in = _B_setup()

    return {
        "A_x": _A_in["x"],
        "A_w_r": _A_in["w_r"],
        "A_w_i": _A_in["w_i"],
        "B_u": _B_in["u"],
        "B_A_re": _B_in["A_re"],
        "B_A_im": _B_in["A_im"],
        "B_B_re": _B_in["B_re"],
        "B_B_im": _B_in["B_im"],
        "B_C_re": _B_in["C_re"],
        "B_C_im": _B_in["C_im"],
        "B_log_dt": _B_in["log_dt"],
        "B_Dskip": _B_in["Dskip"],
    }

def reference(A_x, A_w_r, A_w_i, B_u, B_A_re, B_A_im, B_B_re, B_B_im, B_C_re, B_C_im, B_log_dt, B_Dskip):
    def _A_ref(x, w_r, w_i):
        B, S, D = x.shape
        X = (lambda x, axes=(-2,-1): torch.fft.rfft2(x.float(), dim=axes))(x, axes=(-2, -1))
        W = w_r + 1j * w_i
        X = X * W
        y = (lambda x, s, axes=(-2,-1): torch.fft.irfft2(x, s=s, dim=axes).to(torch.bfloat16))(X, (S, D), axes=(-2, -1))
        return y

    def _B_ref(u, A_re, A_im, B_re, B_im, C_re, C_im, log_dt, Dskip):
        Bsz, L, D = u.shape
        dt = torch.exp(log_dt)[:, None]
        A = A_re + 1j * A_im
        Bc = B_re + 1j * B_im
        Cc = C_re + 1j * C_im
        logdA = dt * A
        dB = dt * Bc
        l = (lambda x, dt: x.to(dt))(torch.arange(L), A_re.dtype)
        P = torch.exp(logdA[:, :, None] * l[None, None, :])
        K = torch.einsum("dn,dnl,dn->dl", Cc, P, dB).real
        L2 = 2 * L
        Kp = _pad(K, ((0, 0), (0, L)))
        up = (lambda x, *d: x.permute(*d))(u, 0, 2, 1)
        up = _pad(up, ((0, 0), (0, 0), (0, L)))
        Kf = (lambda x, axes=(-2,-1): torch.fft.rfft2(x.float(), dim=axes))(Kp[:, None, :], axes=(-2, -1))
        Uf = (lambda x, axes=(-2,-1): torch.fft.rfft2(x.float(), dim=axes))(up[:, :, None, :], axes=(-2, -1))
        Yf = Uf * Kf[None, :, :, :]
        y = (lambda x, s, axes=(-2,-1): torch.fft.irfft2(x, s=s, dim=axes).to(torch.bfloat16))(Yf, (1, L2), axes=(-2, -1))[:, :, 0, :L]
        y = (lambda x, *d: x.permute(*d))(y, 0, 2, 1) + u * Dskip[None, None, :]
        return y

    a = _A_ref(A_x, A_w_r, A_w_i)
    b = _B_ref(B_u, B_A_re, B_A_im, B_B_re, B_B_im, B_C_re, B_C_im, B_log_dt, B_Dskip)
    return torch.concatenate([a, b], axis=-1)
```

```asm
; @launch grid=(512,1,1) block=(256,1,1) lds=81920
.amdgcn_target "amdgcn-amd-amdhsa--gfx950"
.text
.globl concat_heads__spectral_gfnet__ssm_conv_s4__prompt_kernel
.p2align 8
.type concat_heads__spectral_gfnet__ssm_conv_s4__prompt_kernel,@function
concat_heads__spectral_gfnet__ssm_conv_s4__prompt_kernel:
    s_cmp_ge_u32 s2, 256
    s_cbranch_scc1 L_B
    s_setprio 1
    s_getpc_b64 s[38:39]
L_pcA:
    s_load_dwordx16 s[4:19], s[0:1], 0
    s_lshr_b32 s36, s2, 3
    v_lshrrev_b32 v3, 6, v0
    v_and_b32 v1, 63, v0
    s_lshl_b32 s37, s36, 10
    v_lshl_add_u32 v4, v3, 1, v1
    v_lshl_add_u32 v4, v4, 7, s37
    v_min_u32 v4, L_codeend-L_pcA-64, v4
    s_mov_b64 exec, 3
    global_load_dword v4, v4, s[38:39]
    s_mov_b64 exec, -1
    v_readfirstlane_b32 s32, v3
    s_load_dwordx8 s[20:27], s[0:1], 64
    s_load_dwordx2 s[28:29], s[0:1], 96
    s_load_dwordx2 s[30:31], s[0:1], 112
    v_lshlrev_b32 v2, 4, v1
    s_and_b32 s33, s2, 7
    s_lshl_b32 s33, s33, 5
    s_add_u32 s33, s33, s36
    s_lshl2_add_u32 s44, s33, s32
    s_lshl_b32 s47, s32, 8
    s_add_u32 s47, s47, s33
    s_mul_i32 s37, s32, 4608
    s_add_u32 m0, s37, 16384
    s_lshl_b32 s36, s47, 12
    s_waitcnt lgkmcnt(0)
    s_add_u32 s38, s4, s36
    s_addc_u32 s39, s5, 0
    global_load_lds_dwordx4 v2, s[38:39]
    global_load_lds_dwordx4 v2, s[38:39] offset:1024
    s_add_u32 m0, s37, 16512
    s_nop 0
    global_load_lds_dwordx4 v2, s[38:39] offset:2048
    global_load_lds_dwordx4 v2, s[38:39] offset:3072
    s_add_u32 s42, s30, 21102592
    s_addc_u32 s43, s31, 0
    s_lshr_b32 s46, s33, 4
    s_lshl_b32 s36, s46, 7
    s_add_u32 s36, s36, 256
    s_load_dword s41, s[42:43], s36
    s_load_dword s40, s[42:43], 0
    s_lshr_b32 s34, s33, 6
    s_and_b32 s35, s33, 63
    s_and_b32 s45, s33, 15
    v_and_b32 v12, 1, v1
    v_sub_u32 v9, 0, v12
    v_or_b32 v3, 1, v9
    v_and_b32 v11, 8, v1
    v_lshlrev_b32 v6, 7, v11
    v_and_b32 v11, 4, v1
    v_mul_u32_u24 v12, 544, v11
    v_lshlrev_b32 v11, 8, v11
    v_mul_i32_i24 v5, v3, v11
    s_mul_i32 s36, s32, 4608
    s_add_u32 s36, s36, 16384
    v_and_b32 v11, 0x2b, v1
    v_lshl_add_u32 v12, v11, 3, v12
    v_and_b32 v11, 16, v1
    v_lshl_add_u32 v11, v11, 1, v12
    v_add_u32 v7, s36, v11
    v_and_b32 v11, 31, v1
    v_mul_u32_u24 v11, 144, v11
    v_and_b32 v12, 32, v1
    v_add3_u32 v8, v11, v12, s36
    v_lshrrev_b32 v11, 3, v1
    v_and_b32 v12, 0x70, v2
    v_lshl_add_u32 v10, v11, 11, v12
    s_movk_i32 s37, 1026
    v_mad_i32_i24 v12, v3, s44, v5
    v_and_b32 v12, 0x7ff, v12
    v_mad_u32_u24 v12, v12, s37, v6
    s_mov_b64 exec, 0x3333
    global_load_ushort v11, v12, s[6:7]
    s_mov_b64 exec, 0xcccc
    global_load_ushort v11, v12, s[8:9]
    s_mov_b64 exec, -1
    s_lshl_b32 s48, s45, 18
    s_lshl_b32 s36, s32, 16
    s_add_u32 s48, s48, s36
    s_lshl_b32 s36, s46, 7
    s_add_u32 s48, s48, s36
    s_mov_b32 s52, s10
    s_mov_b32 s53, s11
    s_mov_b32 s54, 4194304
    s_mov_b32 s55, 0x20000
    s_lshl_b32 s49, s32, 12
    s_add_u32 s49, s49, 34816
    v_and_b32 v3, 0x13, v1
    v_bfe_u32 v5, v1, 2, 1
    v_lshl_or_b32 v3, v5, 3, v3
    v_bfe_u32 v5, v1, 3, 1
    v_lshl_or_b32 v3, v5, 2, v3
    v_lshrrev_b32 v5, 5, v1
    v_cvt_f32_u32 v3, v3
    v_cvt_f32_u32 v5, v5
    v_mul_f32 v3, 0x3d000000, v3
    v_mul_f32 v5, v5, v3
    v_mul_f32 v5, 4.0, v5
    v_and_b32 v48, 0x80008000, v9
    v_fmamk_f32 v6, v3, 0x0, v5
    v_cos_f32 v44, v6
    v_sin_f32 v45, v6
    v_mul_f32 v6, 0x3d000000, v6
    v_cvt_pk_bf16_f32 v46, v44, v45
    v_cos_f32 v12, v6
    v_cvt_pk_bf16_f32 v47, -v45, v44
    v_sin_f32 v28, v6
    v_fmac_f32 v6, 0.5, v3
    v_accvgpr_write_b32 a0, v46
    v_accvgpr_write_b32 a16, v47
    v_cos_f32 v20, v6
    v_xor_b32 v46, v48, v46
    v_xor_b32 v47, v48, v47
    v_sin_f32 v36, v6
    v_accvgpr_write_b32 a8, v46
    v_accvgpr_write_b32 a24, v47
    v_fmamk_f32 v6, v3, 0x3f800000, v5
    v_cos_f32 v44, v6
    v_sin_f32 v45, v6
    v_mul_f32 v6, 0x3d000000, v6
    v_cvt_pk_bf16_f32 v46, v44, v45
    v_cos_f32 v13, v6
    v_cvt_pk_bf16_f32 v47, -v45, v44
    v_sin_f32 v29, v6
    v_fmac_f32 v6, 0.5, v3
    v_accvgpr_write_b32 a1, v46
    v_accvgpr_write_b32 a17, v47
    v_cos_f32 v21, v6
    v_xor_b32 v46, v48, v46
    v_xor_b32 v47, v48, v47
    v_sin_f32 v37, v6
    v_accvgpr_write_b32 a9, v46
    v_accvgpr_write_b32 a25, v47
    v_fmamk_f32 v6, v3, 0x40000000, v5
    v_cos_f32 v44, v6
    v_sin_f32 v45, v6
    v_mul_f32 v6, 0x3d000000, v6
    v_cvt_pk_bf16_f32 v46, v44, v45
    v_cos_f32 v14, v6
    v_cvt_pk_bf16_f32 v47, -v45, v44
    v_sin_f32 v30, v6
    v_fmac_f32 v6, 0.5, v3
    v_accvgpr_write_b32 a2, v46
    v_accvgpr_write_b32 a18, v47
    v_cos_f32 v22, v6
    v_xor_b32 v46, v48, v46
    v_xor_b32 v47, v48, v47
    v_sin_f32 v38, v6
    v_accvgpr_write_b32 a10, v46
    v_accvgpr_write_b32 a26, v47
    v_fmamk_f32 v6, v3, 0x40400000, v5
    v_cos_f32 v44, v6
    v_sin_f32 v45, v6
    v_mul_f32 v6, 0x3d000000, v6
    v_cvt_pk_bf16_f32 v46, v44, v45
    v_cos_f32 v15, v6
    v_cvt_pk_bf16_f32 v47, -v45, v44
    v_sin_f32 v31, v6
    v_fmac_f32 v6, 0.5, v3
    v_accvgpr_write_b32 a3, v46
    v_accvgpr_write_b32 a19, v47
    v_cos_f32 v23, v6
    v_xor_b32 v46, v48, v46
    v_xor_b32 v47, v48, v47
    v_sin_f32 v39, v6
    v_accvgpr_write_b32 a11, v46
    v_accvgpr_write_b32 a27, v47
    v_fmamk_f32 v6, v3, 0x41000000, v5
    v_cos_f32 v44, v6
    v_sin_f32 v45, v6
    v_mul_f32 v6, 0x3d000000, v6
    v_cvt_pk_bf16_f32 v46, v44, v45
    v_cos_f32 v16, v6
    v_cvt_pk_bf16_f32 v47, -v45, v44
    v_sin_f32 v32, v6
    v_fmac_f32 v6, 0.5, v3
    v_accvgpr_write_b32 a4, v46
    v_accvgpr_write_b32 a20, v47
    v_cos_f32 v24, v6
    v_xor_b32 v46, v48, v46
    v_xor_b32 v47, v48, v47
    v_sin_f32 v40, v6
    v_accvgpr_write_b32 a12, v46
    v_accvgpr_write_b32 a28, v47
    v_fmamk_f32 v6, v3, 0x41100000, v5
    v_cos_f32 v44, v6
    v_sin_f32 v45, v6
    v_mul_f32 v6, 0x3d000000, v6
    v_cvt_pk_bf16_f32 v46, v44, v45
    v_cos_f32 v17, v6
    v_cvt_pk_bf16_f32 v47, -v45, v44
    v_sin_f32 v33, v6
    v_fmac_f32 v6, 0.5, v3
    v_accvgpr_write_b32 a5, v46
    v_accvgpr_write_b32 a21, v47
    v_cos_f32 v25, v6
    v_xor_b32 v46, v48, v46
    v_xor_b32 v47, v48, v47
    v_sin_f32 v41, v6
    v_accvgpr_write_b32 a13, v46
    v_accvgpr_write_b32 a29, v47
    v_fmamk_f32 v6, v3, 0x41200000, v5
    v_cos_f32 v44, v6
    v_sin_f32 v45, v6
    v_mul_f32 v6, 0x3d000000, v6
    v_cvt_pk_bf16_f32 v46, v44, v45
    v_cos_f32 v18, v6
    v_cvt_pk_bf16_f32 v47, -v45, v44
    v_sin_f32 v34, v6
    v_fmac_f32 v6, 0.5, v3
    v_accvgpr_write_b32 a6, v46
    v_accvgpr_write_b32 a22, v47
    v_cos_f32 v26, v6
    v_xor_b32 v46, v48, v46
    v_xor_b32 v47, v48, v47
    v_sin_f32 v42, v6
    v_accvgpr_write_b32 a14, v46
    v_accvgpr_write_b32 a30, v47
    v_fmamk_f32 v6, v3, 0x41300000, v5
    v_cos_f32 v44, v6
    v_sin_f32 v45, v6
    v_mul_f32 v6, 0x3d000000, v6
    v_cvt_pk_bf16_f32 v46, v44, v45
    v_cos_f32 v19, v6
    v_cvt_pk_bf16_f32 v47, -v45, v44
    v_sin_f32 v35, v6
    v_fmac_f32 v6, 0.5, v3
    v_accvgpr_write_b32 a7, v46
    v_accvgpr_write_b32 a23, v47
    v_cos_f32 v27, v6
    v_xor_b32 v46, v48, v46
    v_xor_b32 v47, v48, v47
    v_sin_f32 v43, v6
    v_accvgpr_write_b32 a15, v46
    v_accvgpr_write_b32 a31, v47
    s_add_u32 m0, s49, 0
    s_nop 0
    buffer_load_dwordx4 v10, s[52:55], s48 offen lds
    s_add_u32 m0, s49, 1024
    s_add_u32 s48, s48, 16384
    buffer_load_dwordx4 v10, s[52:55], s48 offen lds
    s_add_u32 m0, s49, 2048
    s_add_u32 s48, s48, 16384
    buffer_load_dwordx4 v10, s[52:55], s48 offen lds
    s_add_u32 m0, s49, 3072
    s_add_u32 s48, s48, 16384
    buffer_load_dwordx4 v10, s[52:55], s48 offen lds
    s_waitcnt vmcnt(6)
    ds_read_b64_tr_b16 v[56:57], v7 offset:0
    ds_read_b64_tr_b16 v[58:59], v7 offset:128
    ds_read_b64_tr_b16 v[60:61], v7 offset:512
    ds_read_b64_tr_b16 v[62:63], v7 offset:640
    ds_read_b64_tr_b16 v[64:65], v7 offset:1024
    ds_read_b64_tr_b16 v[66:67], v7 offset:1152
    ds_read_b64_tr_b16 v[68:69], v7 offset:1536
    ds_read_b64_tr_b16 v[70:71], v7 offset:1664
    s_waitcnt lgkmcnt(6)
    v_mfma_f32_32x32x16_bf16 v[72:87], v[56:59], a[0:3], 0
    v_and_b32 v49, 15, v1
    v_bfe_u32 v50, v1, 4, 1
    v_lshl_add_u32 v48, v49, 1, v50
    v_cmp_gt_u32 s[50:51], 32, v1
    v_lshlrev_b32 v49, 2, v48
    v_mfma_f32_32x32x16_bf16 v[88:103], v[56:59], a[16:19], 0
    v_sub_u32 v50, 4592, v49
    s_and_b32 s48, s32, 1
    s_lshl_b32 s48, s48, 2
    s_and_b32 s49, s32, 2
    s_add_u32 s48, s48, s49
    s_waitcnt lgkmcnt(4)
    v_mfma_f32_32x32x16_bf16 v[72:87], v[60:63], a[4:7], v[72:87]
    s_mul_i32 s48, s48, 288
    v_cndmask_b32 v49, v50, v49, s[50:51]
    v_cndmask_b32 v51, -1, 1, s[50:51]
    v_add_u32 v49, 16384, v49
    v_mad_i32_i24 v3, v51, s48, v49
    v_mfma_f32_32x32x16_bf16 v[88:103], v[60:63], a[20:23], v[88:103]
    v_mul_i32_i24 v51, 144, v51
    v_add_u32 v5, v3, v51
    v_mov_b32 v49, 16384
    v_mov_b32 v50, 18688
    v_cndmask_b32 v45, v49, v50, s[50:51]
    s_waitcnt lgkmcnt(2)
    v_mfma_f32_32x32x16_bf16 v[72:87], v[64:67], a[8:11], v[72:87]
    s_mov_b32 exec_lo, 0
    s_mov_b32 exec_hi, 1
    v_add_u32 v5, 16, v5
    s_lshl_b32 s49, s32, 3
    s_lshr_b32 s49, 0x18141c10, s49
    s_and_b32 s49, s49, 0xff
    s_mul_i32 s49, s49, 144
    s_add_u32 s49, s49, 16384
    v_mov_b32 v3, s49
    s_mov_b64 exec, -1
    v_mfma_f32_32x32x16_bf16 v[88:103], v[64:67], a[24:27], v[88:103]
    v_add_u32 v6, v5, v51
    v_add_u32 v10, v6, v51
    v_bfe_u32 v49, v1, 2, 2
    v_lshrrev_b32 v51, 4, v1
    v_lshl_add_u32 v50, v51, 6, v49
    s_waitcnt lgkmcnt(0)
    v_mfma_f32_32x32x16_bf16 v[72:87], v[68:71], a[12:15], v[72:87]
    v_and_b32 v48, 0x30, v2
    v_lshl_add_u32 v44, v50, 14, v48
    v_and_b32 v50, 4, v9
    v_lshl_add_u32 v50, v49, 3, v50
    v_and_b32 v48, 32, v48
    v_mfma_f32_32x32x16_bf16 v[88:103], v[68:71], a[28:31], v[88:103]
    v_add_u32 v46, v50, v48
    v_lshlrev_b32 v47, 26, v48
    v_cvt_f32_u32 v49, v49
    v_mul_f32 v48, 0x3a800000, v49
    v_and_b32 v54, 0x3e800000, v9
    s_nop 0
    v_pk_mul_f32 v[104:105], v[72:73], v[12:13]
    s_nop 4
    v_pk_mul_f32 v[106:107], v[88:89], v[12:13]
    v_pk_mul_f32 v[108:109], v[74:75], v[14:15]
    v_pk_mul_f32 v[110:111], v[90:91], v[14:15]
    v_pk_fma_f32 v[104:105], v[88:89], v[28:29], v[104:105]
    v_pk_fma_f32 v[106:107], v[72:73], v[28:29], v[106:107] neg_lo:[1,0,0] neg_hi:[1,0,0]
    v_and_b32 v49, 2, v1
    v_cmp_eq_u32 s[50:51], v49, v51
    v_add_u32 v49, 1, v49
    v_cmp_eq_u32 vcc, v49, v51
    v_cndmask_b32 v52, 0, -1, s[50:51]
    v_pk_fma_f32 v[108:109], v[90:91], v[30:31], v[108:109]
    v_pk_fma_f32 v[110:111], v[74:75], v[30:31], v[110:111] neg_lo:[1,0,0] neg_hi:[1,0,0]
    v_cvt_pk_bf16_f32 v56, v104, v106
    v_cvt_pk_bf16_f32 v57, v105, v107
    v_cvt_pk_bf16_f32 v58, v108, v110
    v_cvt_pk_bf16_f32 v59, v109, v111
    s_nop 0
    v_cndmask_b32 v53, 0, -1, vcc
    v_cvt_f32_u32 v49, s33
    v_fmac_f32 v54, v49, v48
    v_fmamk_f32 v49, v48, 0x0, v54
    v_pk_mul_f32 v[104:105], v[76:77], v[16:17]
    v_pk_mul_f32 v[106:107], v[92:93], v[16:17]
    v_pk_mul_f32 v[108:109], v[78:79], v[18:19]
    v_pk_mul_f32 v[110:111], v[94:95], v[18:19]
    v_pk_fma_f32 v[104:105], v[92:93], v[32:33], v[104:105]
    v_pk_fma_f32 v[106:107], v[76:77], v[32:33], v[106:107] neg_lo:[1,0,0] neg_hi:[1,0,0]
    v_sin_f32 v50, v49
    v_cos_f32 v51, v49
    v_xor_b32 v50, v47, v50
    v_cvt_pk_bf16_f32 v51, v51, v50
    v_and_b32 v50, v52, v51
    v_pk_fma_f32 v[108:109], v[94:95], v[34:35], v[108:109]
    v_pk_fma_f32 v[110:111], v[78:79], v[34:35], v[110:111] neg_lo:[1,0,0] neg_hi:[1,0,0]
    v_cvt_pk_bf16_f32 v60, v104, v106
    v_cvt_pk_bf16_f32 v61, v105, v107
    v_cvt_pk_bf16_f32 v62, v108, v110
    v_cvt_pk_bf16_f32 v63, v109, v111
    v_and_b32 v51, v53, v51
    v_accvgpr_write_b32 a32, v50
    v_accvgpr_write_b32 a36, v51
    v_fmamk_f32 v49, v48, 0x43800000, v54
    v_sin_f32 v50, v49
    v_pk_mul_f32 v[104:105], v[80:81], v[20:21]
    v_pk_mul_f32 v[106:107], v[96:97], v[20:21]
    v_pk_mul_f32 v[108:109], v[82:83], v[22:23]
    v_pk_mul_f32 v[110:111], v[98:99], v[22:23]
    v_pk_fma_f32 v[104:105], v[96:97], v[36:37], v[104:105]
    v_pk_fma_f32 v[106:107], v[80:81], v[36:37], v[106:107] neg_lo:[1,0,0] neg_hi:[1,0,0]
    v_cos_f32 v51, v49
    v_xor_b32 v50, v47, v50
    v_cvt_pk_bf16_f32 v51, v51, v50
    v_and_b32 v50, v52, v51
    v_and_b32 v51, v53, v51
    v_pk_fma_f32 v[108:109], v[98:99], v[38:39], v[108:109]
    v_pk_fma_f32 v[110:111], v[82:83], v[38:39], v[110:111] neg_lo:[1,0,0] neg_hi:[1,0,0]
    v_cvt_pk_bf16_f32 v64, v104, v106
    v_cvt_pk_bf16_f32 v65, v105, v107
    v_cvt_pk_bf16_f32 v66, v108, v110
    v_cvt_pk_bf16_f32 v67, v109, v111
    v_accvgpr_write_b32 a33, v50
    v_accvgpr_write_b32 a37, v51
    v_fmamk_f32 v49, v48, 0x44000000, v54
    v_sin_f32 v50, v49
    v_cos_f32 v51, v49
    v_pk_mul_f32 v[104:105], v[84:85], v[24:25]
    v_pk_mul_f32 v[106:107], v[100:101], v[24:25]
    v_pk_mul_f32 v[108:109], v[86:87], v[26:27]
    v_pk_mul_f32 v[110:111], v[102:103], v[26:27]
    v_pk_fma_f32 v[104:105], v[100:101], v[40:41], v[104:105]
    v_pk_fma_f32 v[106:107], v[84:85], v[40:41], v[106:107] neg_lo:[1,0,0] neg_hi:[1,0,0]
    v_xor_b32 v50, v47, v50
    v_cvt_pk_bf16_f32 v51, v51, v50
    v_and_b32 v50, v52, v51
    v_and_b32 v51, v53, v51
    v_accvgpr_write_b32 a34, v50
    v_pk_fma_f32 v[108:109], v[102:103], v[42:43], v[108:109]
    v_pk_fma_f32 v[110:111], v[86:87], v[42:43], v[110:111] neg_lo:[1,0,0] neg_hi:[1,0,0]
    v_cvt_pk_bf16_f32 v68, v104, v106
    v_cvt_pk_bf16_f32 v69, v105, v107
    v_cvt_pk_bf16_f32 v70, v108, v110
    v_cvt_pk_bf16_f32 v71, v109, v111
    v_accvgpr_write_b32 a38, v51
    v_fmamk_f32 v49, v48, 0x44400000, v54
    v_sin_f32 v50, v49
    v_cos_f32 v51, v49
    v_xor_b32 v50, v47, v50
    v_mfma_f32_32x32x16_bf16 v[72:87], v[56:59], a[0:3], 0
    v_cvt_pk_bf16_f32 v51, v51, v50
    v_and_b32 v50, v52, v51
    v_and_b32 v51, v53, v51
    v_accvgpr_write_b32 a35, v50
    v_accvgpr_write_b32 a39, v51
    v_mfma_f32_32x32x16_bf16 v[88:103], v[56:59], a[16:19], 0
    v_mfma_f32_32x32x16_bf16 v[72:87], v[60:63], a[4:7], v[72:87]
    v_mfma_f32_32x32x16_bf16 v[88:103], v[60:63], a[20:23], v[88:103]
    v_mfma_f32_32x32x16_bf16 v[72:87], v[64:67], a[8:11], v[72:87]
    v_mfma_f32_32x32x16_bf16 v[88:103], v[64:67], a[24:27], v[88:103]
    v_mfma_f32_32x32x16_bf16 v[72:87], v[68:71], a[12:15], v[72:87]
    v_mfma_f32_32x32x16_bf16 v[88:103], v[68:71], a[28:31], v[88:103]
    s_nop 11
    v_cvt_pk_bf16_f32 v56, v72, v88
    v_cvt_pk_bf16_f32 v57, v73, v89
    v_cvt_pk_bf16_f32 v58, v74, v90
    v_cvt_pk_bf16_f32 v59, v75, v91
    ds_write_b128 v8, v[56:59] offset:0
    v_cvt_pk_bf16_f32 v60, v76, v92
    v_cvt_pk_bf16_f32 v61, v77, v93
    v_cvt_pk_bf16_f32 v62, v78, v94
    v_cvt_pk_bf16_f32 v63, v79, v95
    ds_write_b128 v8, v[60:63] offset:16
    v_cvt_pk_bf16_f32 v64, v80, v96
    v_cvt_pk_bf16_f32 v65, v81, v97
    v_cvt_pk_bf16_f32 v66, v82, v98
    v_cvt_pk_bf16_f32 v67, v83, v99
    ds_write_b128 v8, v[64:67] offset:64
    v_cvt_pk_bf16_f32 v68, v84, v100
    v_cvt_pk_bf16_f32 v69, v85, v101
    v_cvt_pk_bf16_f32 v70, v86, v102
    v_cvt_pk_bf16_f32 v71, v87, v103
    ds_write_b128 v8, v[68:71] offset:80
    s_mov_b32 s48, s30
    s_mov_b32 s49, s31
    s_mov_b32 s50, 268435456
    s_mov_b32 s51, 0x20000
    s_lshl_b32 s52, s32, 18
    s_lshl_b32 s36, s33, 6
    s_add_u32 s52, s52, s36
    s_add_u32 s53, s52, 65536
    s_add_u32 s54, s52, 131072
    s_add_u32 s55, s52, 196608
    s_lshl_b32 s56, s32, 14
    s_lshl_b32 s36, s33, 6
    s_add_u32 s56, s56, s36
    s_add_u32 s56, s56, 21037056
    s_lshl_b32 s57, s46, 18
    s_lshl_b32 s36, s45, 10
    s_add_u32 s57, s57, s36
    s_lshl_b32 s36, s32, 8
    s_add_u32 s57, s57, s36
    s_add_u32 s57, s57, 8388608
    s_waitcnt lgkmcnt(0)
    s_not_b32 s58, s40
    s_mul_i32 s36, s40, 0x9e3779b1
    s_lshr_b32 s37, s36, 15
    s_and_b32 s61, s37, 0x10001
    s_lshr_b32 s37, s36, 14
    s_and_b32 s62, s37, 0x10001
    s_lshr_b32 s37, s36, 13
    s_and_b32 s63, s37, 0x10001
    s_lshr_b32 s37, s36, 12
    s_and_b32 s37, s37, 0x10000
    s_and_b32 s60, s58, 1
    s_or_b32 s60, s60, s37
    v_mov_b32 v48, 0xfffefffe
    s_waitcnt lgkmcnt(0)
    s_barrier
    s_waitcnt vmcnt(4)
    v_lshlrev_b32 v11, 16, v11
    v_and_b32 v50, v9, v47
    v_xor_b32 v11, v11, v50
    v_mov_b32 v51, s58
    s_nop 0
    v_add_f32_dpp v50, v11, v11 quad_perm:[1,0,3,2] row_mask:0xf bank_mask:0xf
    v_mul_f32 v50, 0.5, v50
    s_nop 1
    v_mov_b32_dpp v11, v50 quad_perm:[2,3,0,1] row_mask:0xf bank_mask:0xf
    v_cvt_pk_bf16_f32 v11, v50, v11
    v_bfi_b32 v11, v9, v51, v11
    s_mov_b64 exec, 0xffff
    buffer_store_dword v11, v46, s[48:51], s56 offen sc1
    s_mov_b64 exec, -1
    ds_read2st64_b32 v[56:57], v3 offset0:0 offset1:18
    ds_read2st64_b32 v[58:59], v3 offset0:36 offset1:54
    ds_read2st64_b32 v[60:61], v5 offset0:0 offset1:18
    ds_read2st64_b32 v[62:63], v5 offset0:36 offset1:54
    ds_read2st64_b32 v[64:65], v6 offset0:0 offset1:18
    ds_read2st64_b32 v[66:67], v6 offset0:36 offset1:54
    ds_read2st64_b32 v[68:69], v10 offset0:0 offset1:18
    ds_read2st64_b32 v[70:71], v10 offset0:36 offset1:54
    ds_read2st64_b32 v[104:105], v45 offset0:0 offset1:18
    ds_read2st64_b32 v[106:107], v45 offset0:36 offset1:54
    s_waitcnt lgkmcnt(8)
    v_mfma_f32_16x16x32_bf16 v[72:75], a[32:35], v[56:59], 0
    v_mfma_f32_16x16x32_bf16 v[88:91], a[36:39], v[56:59], 0
    s_waitcnt lgkmcnt(6)
    v_mfma_f32_16x16x32_bf16 v[76:79], a[32:35], v[60:63], 0
    v_mfma_f32_16x16x32_bf16 v[92:95], a[36:39], v[60:63], 0
    s_waitcnt lgkmcnt(4)
    v_mfma_f32_16x16x32_bf16 v[80:83], a[32:35], v[64:67], 0
    v_mfma_f32_16x16x32_bf16 v[96:99], a[36:39], v[64:67], 0
    s_waitcnt lgkmcnt(2)
    v_mfma_f32_16x16x32_bf16 v[84:87], a[32:35], v[68:71], 0
    v_mfma_f32_16x16x32_bf16 v[100:103], a[36:39], v[68:71], 0
    s_waitcnt lgkmcnt(0)
    v_mfma_f32_16x16x32_bf16 v[108:111], a[32:35], v[104:107], 0
    v_cvt_pk_bf16_f32 v56, v72, v73
    v_cvt_pk_bf16_f32 v57, v74, v75
    v_cvt_pk_bf16_f32 v58, v88, v89
    v_cvt_pk_bf16_f32 v59, v90, v91
    v_bfi_b32 v56, v48, v56, s60
    v_bfi_b32 v57, v48, v57, s61
    v_bfi_b32 v58, v48, v58, s62
    v_bfi_b32 v59, v48, v59, s63
    buffer_store_dwordx4 v[56:59], v44, s[48:51], s52 offen sc1
    v_cvt_pk_bf16_f32 v60, v76, v77
    v_cvt_pk_bf16_f32 v61, v78, v79
    v_cvt_pk_bf16_f32 v62, v92, v93
    v_cvt_pk_bf16_f32 v63, v94, v95
    v_bfi_b32 v60, v48, v60, s60
    v_bfi_b32 v61, v48, v61, s61
    v_bfi_b32 v62, v48, v62, s62
    v_bfi_b32 v63, v48, v63, s63
    buffer_store_dwordx4 v[60:63], v44, s[48:51], s53 offen sc1
    v_cvt_pk_bf16_f32 v64, v80, v81
    v_cvt_pk_bf16_f32 v65, v82, v83
    v_cvt_pk_bf16_f32 v66, v96, v97
    v_cvt_pk_bf16_f32 v67, v98, v99
    v_bfi_b32 v64, v48, v64, s60
    v_bfi_b32 v65, v48, v65, s61
    v_bfi_b32 v66, v48, v66, s62
    v_bfi_b32 v67, v48, v67, s63
    buffer_store_dwordx4 v[64:67], v44, s[48:51], s54 offen sc1
    v_cvt_pk_bf16_f32 v68, v84, v85
    v_cvt_pk_bf16_f32 v69, v86, v87
    v_cvt_pk_bf16_f32 v70, v100, v101
    v_cvt_pk_bf16_f32 v71, v102, v103
    v_bfi_b32 v68, v48, v68, s60
    v_bfi_b32 v69, v48, v69, s61
    v_bfi_b32 v70, v48, v70, s62
    v_bfi_b32 v71, v48, v71, s63
    buffer_store_dwordx4 v[68:71], v44, s[48:51], s55 offen sc1
    v_cvt_pk_bf16_f32 v104, v108, v109
    v_cvt_pk_bf16_f32 v106, v110, v111
    v_mov_b32 v105, s58
    v_mov_b32 v107, s58
    v_and_b32 v49, 0x30, v2
    s_lshl_b32 s36, s32, 4
    s_lshl_b64 exec, 15, s36
    s_add_u32 s36, s56, 4294901760
    buffer_store_dwordx4 v[104:107], v49, s[48:51], s36 offen sc1
    s_mov_b64 exec, -1
    s_bitcmp1_b32 s32, 0
    s_cselect_b32 s52, s8, s6
    s_cselect_b32 s53, s9, s7
    s_mov_b32 s54, 2101248
    s_mov_b32 s55, 0x20000
    s_lshr_b32 s59, s32, 1
    v_and_b32 v5, 7, v1
    v_mul_u32_u24 v5, 4104, v5
    v_lshrrev_b32 v3, 3, v1
    v_lshlrev_b32 v3, 7, v3
    v_min_u32 v3, 511, v3
    v_add_u32 v3, v3, v5
    s_and_b32 s64, s33, 31
    s_and_b32 s65, s33, 32
    s_mul_i32 s66, s64, 65664
    s_mul_i32 s36, s59, 32832
    s_add_u32 s66, s66, s36
    s_mul_i32 s36, s34, 1026
    s_add_u32 s66, s66, s36
    s_lshl_b32 s36, s65, 4
    s_add_u32 s66, s66, s36
    s_mov_b32 exec_hi, 0xff
    buffer_load_ubyte v3, v3, s[52:55], s66 offen
    s_mov_b32 exec_hi, -1
    v_and_b32 v7, 3, v1
    v_lshrrev_b32 v8, 2, v1
    v_lshlrev_b32 v6, 4, v7
    v_lshl_add_u32 v6, v8, 14, v6
    v_and_b32 v8, 3, v8
    v_lshl_add_u32 v7, v8, 4, v7
    v_lshrrev_b32 v8, 4, v1
    v_lshl_add_u32 v7, v8, 2, v7
    s_mul_i32 s36, s32, 4096
    v_lshl_add_u32 v5, v7, 3, s36
    s_not_b32 s56, s41
    s_mul_i32 s36, s41, 0x9e3779b1
    s_lshr_b32 s37, s36, 15
    s_and_b32 s53, s37, 0x10001
    s_lshr_b32 s37, s36, 14
    s_and_b32 s54, s37, 0x10001
    s_lshr_b32 s37, s36, 13
    s_and_b32 s55, s37, 0x10001
    s_lshr_b32 s37, s36, 12
    s_and_b32 s37, s37, 0x10000
    s_and_b32 s52, s56, 1
    s_or_b32 s52, s52, s37
    s_waitcnt vmcnt(7)
    ds_read_b64_tr_b16 v[12:13], v5 offset:34816
    ds_read_b64_tr_b16 v[14:15], v5 offset:35328
    ds_read_b64_tr_b16 v[16:17], v5 offset:35840
    ds_read_b64_tr_b16 v[18:19], v5 offset:36352
    ds_read_b64_tr_b16 v[20:21], v5 offset:36864
    ds_read_b64_tr_b16 v[22:23], v5 offset:37376
    ds_read_b64_tr_b16 v[24:25], v5 offset:37888
    ds_read_b64_tr_b16 v[26:27], v5 offset:38400
    s_waitcnt lgkmcnt(6)
    v_bfi_b32 v12, v48, v12, s52
    v_bfi_b32 v13, v48, v13, s53
    v_bfi_b32 v14, v48, v14, s54
    v_bfi_b32 v15, v48, v15, s55
    buffer_store_dwordx4 v[12:15], v6, s[48:51], s57 offen offset:0 sc1
    s_waitcnt lgkmcnt(4)
    v_bfi_b32 v16, v48, v16, s52
    v_bfi_b32 v17, v48, v17, s53
    v_bfi_b32 v18, v48, v18, s54
    v_bfi_b32 v19, v48, v19, s55
    buffer_store_dwordx4 v[16:19], v6, s[48:51], s57 offen offset:64 sc1
    s_waitcnt lgkmcnt(2)
    v_bfi_b32 v20, v48, v20, s52
    v_bfi_b32 v21, v48, v21, s53
    v_bfi_b32 v22, v48, v22, s54
    v_bfi_b32 v23, v48, v23, s55
    buffer_store_dwordx4 v[20:23], v6, s[48:51], s57 offen offset:128 sc1
    s_waitcnt lgkmcnt(0)
    v_bfi_b32 v24, v48, v24, s52
    v_bfi_b32 v25, v48, v25, s53
    v_bfi_b32 v26, v48, v26, s54
    v_bfi_b32 v27, v48, v27, s55
    buffer_store_dwordx4 v[24:27], v6, s[48:51], s57 offen offset:192 sc1
    s_bitcmp1_b32 s32, 0
    s_cselect_b32 s64, s8, s6
    s_cselect_b32 s65, s9, s7
    s_mov_b32 s66, 2101248
    s_mov_b32 s67, 0x20000
    s_lshr_b32 s56, s32, 1
    s_mul_i32 s57, s56, 1050624
    s_mul_i32 s36, s34, 1026
    s_add_u32 s57, s57, s36
    s_lshl_b32 s36, s35, 4
    s_add_u32 s57, s57, s36
    s_mov_b32 s68, s28
    s_mov_b32 s69, s29
    s_mov_b32 s70, 8388608
    s_mov_b32 s71, 0x20000
    s_lshl_b32 s56, s33, 14
    s_lshl_b32 s36, s32, 12
    s_add_u32 s56, s56, s36
    s_lshl_b32 s4, s32, 18
    s_lshl_b32 s36, s33, 6
    s_add_u32 s4, s4, s36
    s_add_u32 s5, s4, 1048576
    s_add_u32 s6, s4, 2097152
    s_add_u32 s7, s4, 3145728
    s_lshl_b32 s8, s46, 18
    s_lshl_b32 s36, s45, 9
    s_add_u32 s8, s8, s36
    s_lshl_b32 s36, s32, 7
    s_add_u32 s8, s8, s36
    s_add_u32 s8, s8, 8388608
    s_lshl_b32 s9, s47, 13
    s_add_u32 s10, s9, 4096
    s_lshl_b32 s11, s45, 18
    s_lshl_b32 s36, s32, 16
    s_add_u32 s11, s11, s36
    s_lshl_b32 s36, s46, 7
    s_add_u32 s11, s11, s36
    s_add_u32 s11, s11, 2048
    v_and_b32 v5, 15, v1
    v_lshrrev_b32 v7, 4, v1
    v_lshrrev_b32 v8, 5, v1
    v_bfe_u32 v9, v1, 2, 2
    v_and_b32 v10, 3, v1
    v_lshrrev_b32 v12, 2, v1
    v_bfe_u32 v13, v1, 4, 1
    v_mul_u32_u24 v20, 4112, v10
    v_lshl_add_u32 v20, v12, 6, v20
    v_lshlrev_b32 v21, 1, v13
    v_xor_b32 v21, s32, v21
    v_lshl_add_u32 v14, v21, 4, v20
    v_and_b32 v21, 1, v9
    v_lshlrev_b32 v21, 1, v21
    v_xor_b32 v21, v7, v21
    v_lshl_add_u32 v21, v5, 2, v21
    s_mul_i32 s36, s32, 4112
    v_lshl_add_u32 v15, v21, 4, s36
    v_bfe_u32 v21, v1, 1, 3
    v_add_u32 v21, s32, v21
    v_and_b32 v21, 3, v21
    v_lshl_add_u32 v21, v5, 2, v21
    v_lshl_add_u32 v21, v7, 8, v21
    v_lshlrev_b32 v16, 4, v21
    s_lshl_b32 s36, s32, 12
    v_add_u32 v17, s36, v2
    v_lshl_add_u32 v19, v1, 2, s36
    v_lshrrev_b32 v20, 3, v1
    v_sub_u32 v20, v1, v20
    v_and_b32 v20, 3, v20
    v_lshlrev_b32 v20, 4, v20
    v_lshl_add_u32 v18, v12, 6, v20
    v_cvt_f32_u32 v10, v5
    v_cvt_f32_u32 v21, v7
    v_mul_f32 v10, 0x3d800000, v10
    v_mul_f32 v13, v21, v10
    v_mul_f32 v13, 4.0, v13
    v_fmamk_f32 v12, v10, 0x0, v13
    v_cos_f32 v9, v12
    v_sin_f32 v8, v12
    v_mul_f32 v12, 0x3d800000, v12
    v_cvt_pk_bf16_f32 v20, v9, v8
    v_cos_f32 v22, v12
    v_cvt_pk_bf16_f32 v21, -v8, v9
    v_sin_f32 v26, v12
    v_accvgpr_write_b32 a32, v20
    v_accvgpr_write_b32 a36, v21
    v_fmamk_f32 v12, v10, 0x3f800000, v13
    v_cos_f32 v9, v12
    v_sin_f32 v8, v12
    v_mul_f32 v12, 0x3d800000, v12
    v_cvt_pk_bf16_f32 v20, v9, v8
    v_cos_f32 v23, v12
    v_cvt_pk_bf16_f32 v21, -v8, v9
    v_sin_f32 v27, v12
    v_accvgpr_write_b32 a33, v20
    v_accvgpr_write_b32 a37, v21
    v_fmamk_f32 v12, v10, 0x40000000, v13
    v_cos_f32 v9, v12
    v_sin_f32 v8, v12
    v_mul_f32 v12, 0x3d800000, v12
    v_cvt_pk_bf16_f32 v20, v9, v8
    v_cos_f32 v24, v12
    v_cvt_pk_bf16_f32 v21, -v8, v9
    v_sin_f32 v28, v12
    v_accvgpr_write_b32 a34, v20
    v_accvgpr_write_b32 a38, v21
    v_fmamk_f32 v12, v10, 0x40400000, v13
    v_cos_f32 v9, v12
    v_sin_f32 v8, v12
    v_mul_f32 v12, 0x3d800000, v12
    v_cvt_pk_bf16_f32 v20, v9, v8
    v_cos_f32 v25, v12
    v_cvt_pk_bf16_f32 v21, -v8, v9
    v_sin_f32 v29, v12
    v_accvgpr_write_b32 a35, v20
    v_accvgpr_write_b32 a39, v21
    v_lshl_add_u32 v9, v7, 6, v5
    v_lshl_add_u32 v9, v9, 2, s34
    v_cvt_f32_u32 v9, v9
    v_mul_f32 v9, 0x3a000000, v9
    v_add_f32 v12, 0x0, v9
    v_sin_f32 v30, v12
    v_cos_f32 v34, v12
    v_add_f32 v12, 0x3d000000, v9
    v_sin_f32 v31, v12
    v_cos_f32 v35, v12
    v_add_f32 v12, 0x3d800000, v9
    v_sin_f32 v32, v12
    v_cos_f32 v36, v12
    v_add_f32 v12, 0x3dc00000, v9
    v_sin_f32 v33, v12
    v_cos_f32 v37, v12
    v_lshrrev_b32 v12, 4, v1
    v_bfe_u32 v20, v1, 2, 1
    v_cmp_eq_u32 vcc, v20, v12
    v_add_u32 v20, 2, v20
    v_and_b32 v21, 15, v1
    v_cndmask_b32 v8, 0, -1, vcc
    v_cmp_eq_u32 vcc, v20, v12
    v_lshl_add_u32 v21, v12, 6, v21
    v_mul_u32_u24 v10, 4104, v21
    v_cndmask_b32 v9, 0, -1, vcc
    v_bfe_u32 v20, v1, 3, 1
    v_bfe_u32 v21, v1, 1, 1
    v_lshl_add_u32 v20, v20, 1, v21
    v_cvt_f32_u32 v20, v20
    v_mul_f32 v5, 0x3e800000, v20
    v_and_b32 v21, 1, v1
    v_cvt_f32_u32 v21, v21
    v_mul_f32 v7, 0xbe800000, v21
    v_cvt_f32_u32 v12, s33
    v_fmamk_f32 v5, v12, 0x3a800000, v5
    v_fmamk_f32 v13, v5, 0x0, v7
    v_cos_f32 v20, v13
    v_sin_f32 v21, v13
    v_mul_f32 v20, 0x35000000, v20
    v_mul_f32 v21, 0xb5000000, v21
    v_cvt_pk_bf16_f32 v38, v20, v21
    v_and_b32 v12, v8, v38
    v_and_b32 v38, v9, v38
    v_accvgpr_write_b32 a40, v12
    v_accvgpr_write_b32 a44, v38
    v_fmamk_f32 v13, v5, 0x3f800000, v7
    v_cos_f32 v20, v13
    v_sin_f32 v21, v13
    v_mul_f32 v20, 0x35000000, v20
    v_mul_f32 v21, 0xb5000000, v21
    v_cvt_pk_bf16_f32 v38, v20, v21
    v_and_b32 v12, v8, v38
    v_and_b32 v38, v9, v38
    v_accvgpr_write_b32 a41, v12
    v_accvgpr_write_b32 a45, v38
    v_fmamk_f32 v13, v5, 0x40000000, v7
    v_cos_f32 v20, v13
    v_sin_f32 v21, v13
    v_mul_f32 v20, 0x35000000, v20
    v_mul_f32 v21, 0xb5000000, v21
    v_cvt_pk_bf16_f32 v38, v20, v21
    v_and_b32 v12, v8, v38
    v_and_b32 v38, v9, v38
    v_accvgpr_write_b32 a42, v12
    v_accvgpr_write_b32 a46, v38
    v_fmamk_f32 v13, v5, 0x40400000, v7
    v_cos_f32 v20, v13
    v_sin_f32 v21, v13
    v_mul_f32 v20, 0x35000000, v20
    v_mul_f32 v21, 0xb5000000, v21
    v_cvt_pk_bf16_f32 v38, v20, v21
    v_and_b32 v12, v8, v38
    v_and_b32 v38, v9, v38
    v_accvgpr_write_b32 a43, v12
    v_accvgpr_write_b32 a47, v38
    s_cmp_eq_u32 s35, 0
    s_cbranch_scc1 Lsp1
    s_waitcnt vmcnt(4)
    s_add_u32 s12, s57, 0
    buffer_load_dwordx4 v[66:69], v10, s[64:67], s12 offen
    s_add_u32 s12, s57, 65664
    buffer_load_dwordx4 v[70:73], v10, s[64:67], s12 offen
    s_add_u32 s12, s57, 131328
    buffer_load_dwordx4 v[74:77], v10, s[64:67], s12 offen
    s_add_u32 s12, s57, 196992
    buffer_load_dwordx4 v[78:81], v10, s[64:67], s12 offen
    s_waitcnt vmcnt(4)
    s_sleep 16
    buffer_load_dwordx4 v[50:53], v2, s[48:51], s56 offen offset:0 sc1
    buffer_load_dwordx4 v[54:57], v2, s[48:51], s56 offen offset:1024 sc1
    buffer_load_dwordx4 v[58:61], v2, s[48:51], s56 offen offset:2048 sc1
    buffer_load_dwordx4 v[62:65], v2, s[48:51], s56 offen offset:3072 sc1
    s_waitcnt vmcnt(4)
    s_lshl_b32 s36, s32, 10
    s_add_u32 m0, s36, 0
    s_nop 0
    ds_write_addtid_b32 v66 offset:0
    ds_write_addtid_b32 v67 offset:4096
    ds_write_addtid_b32 v68 offset:8192
    ds_write_addtid_b32 v69 offset:12288
    ds_write_addtid_b32 v70 offset:256
    ds_write_addtid_b32 v71 offset:4352
    ds_write_addtid_b32 v72 offset:8448
    ds_write_addtid_b32 v73 offset:12544
    ds_write_addtid_b32 v74 offset:512
    ds_write_addtid_b32 v75 offset:4608
    ds_write_addtid_b32 v76 offset:8704
    ds_write_addtid_b32 v77 offset:12800
    ds_write_addtid_b32 v78 offset:768
    ds_write_addtid_b32 v79 offset:4864
    ds_write_addtid_b32 v80 offset:8960
    ds_write_addtid_b32 v81 offset:13056
    s_waitcnt lgkmcnt(0)
    s_barrier
    ds_read2st64_b32 v[66:67], v19 offset0:0 offset1:1
    ds_read2st64_b32 v[68:69], v19 offset0:2 offset1:3
    ds_read2st64_b32 v[70:71], v19 offset0:4 offset1:5
    ds_read2st64_b32 v[72:73], v19 offset0:6 offset1:7
    ds_read2st64_b32 v[74:75], v19 offset0:8 offset1:9
    ds_read2st64_b32 v[76:77], v19 offset0:10 offset1:11
    ds_read2st64_b32 v[78:79], v19 offset0:12 offset1:13
    ds_read2st64_b32 v[80:81], v19 offset0:14 offset1:15
    s_waitcnt lgkmcnt(0)
    v_and_b32 v106, 0xffff0000, v66
    v_and_b32 v107, 0xffff0000, v67
    v_and_b32 v108, 0xffff0000, v68
    v_and_b32 v109, 0xffff0000, v69
    v_and_b32 v110, 0xffff0000, v70
    v_and_b32 v111, 0xffff0000, v71
    v_and_b32 v112, 0xffff0000, v72
    v_and_b32 v113, 0xffff0000, v73
    v_and_b32 v114, 0xffff0000, v74
    v_and_b32 v115, 0xffff0000, v75
    v_and_b32 v116, 0xffff0000, v76
    v_and_b32 v117, 0xffff0000, v77
    v_and_b32 v118, 0xffff0000, v78
    v_and_b32 v119, 0xffff0000, v79
    v_and_b32 v120, 0xffff0000, v80
    v_and_b32 v121, 0xffff0000, v81
    v_pk_add_f32 v[186:187], v[106:107], v[114:115] neg_lo:[0,1] neg_hi:[0,1]
    v_pk_add_f32 v[106:107], v[106:107], v[114:115]
    v_pk_add_f32 v[190:191], v[110:111], v[118:119] neg_lo:[0,1] neg_hi:[0,1]
    v_pk_add_f32 v[110:111], v[110:111], v[118:119]
    v_pk_fma_f32 v[170:171], v[30:31], v[186:187], v[106:107] neg_lo:[1,0,0] neg_hi:[1,0,0]
    v_pk_fma_f32 v[178:179], v[30:31], v[186:187], v[106:107]
    v_pk_fma_f32 v[174:175], v[30:31], v[190:191], v[110:111] neg_lo:[1,0,0] neg_hi:[1,0,0]
    v_pk_fma_f32 v[182:183], v[30:31], v[190:191], v[110:111]
    v_pk_mul_f32 v[186:187], v[34:35], v[186:187]
    v_pk_mul_f32 v[190:191], v[34:35], v[190:191]
    v_pk_add_f32 v[188:189], v[108:109], v[116:117] neg_lo:[0,1] neg_hi:[0,1]
    v_pk_add_f32 v[108:109], v[108:109], v[116:117]
    v_pk_add_f32 v[192:193], v[112:113], v[120:121] neg_lo:[0,1] neg_hi:[0,1]
    v_pk_add_f32 v[112:113], v[112:113], v[120:121]
    v_pk_fma_f32 v[172:173], v[32:33], v[188:189], v[108:109] neg_lo:[1,0,0] neg_hi:[1,0,0]
    v_pk_fma_f32 v[180:181], v[32:33], v[188:189], v[108:109]
    v_pk_fma_f32 v[176:177], v[32:33], v[192:193], v[112:113] neg_lo:[1,0,0] neg_hi:[1,0,0]
    v_pk_fma_f32 v[184:185], v[32:33], v[192:193], v[112:113]
    v_pk_mul_f32 v[188:189], v[36:37], v[188:189]
    v_pk_mul_f32 v[192:193], v[36:37], v[192:193]
    v_lshlrev_b32 v106, 16, v66
    v_lshlrev_b32 v107, 16, v67
    v_lshlrev_b32 v108, 16, v68
    v_lshlrev_b32 v109, 16, v69
    v_lshlrev_b32 v110, 16, v70
    v_lshlrev_b32 v111, 16, v71
    v_lshlrev_b32 v112, 16, v72
    v_lshlrev_b32 v113, 16, v73
    v_lshlrev_b32 v114, 16, v74
    v_lshlrev_b32 v115, 16, v75
    v_lshlrev_b32 v116, 16, v76
    v_lshlrev_b32 v117, 16, v77
    v_lshlrev_b32 v118, 16, v78
    v_lshlrev_b32 v119, 16, v79
    v_lshlrev_b32 v120, 16, v80
    v_lshlrev_b32 v121, 16, v81
    v_pk_add_f32 v[162:163], v[106:107], v[114:115] neg_lo:[0,1] neg_hi:[0,1]
    v_pk_add_f32 v[106:107], v[106:107], v[114:115]
    v_pk_add_f32 v[166:167], v[110:111], v[118:119] neg_lo:[0,1] neg_hi:[0,1]
    v_pk_add_f32 v[110:111], v[110:111], v[118:119]
    v_pk_fma_f32 v[38:39], v[30:31], v[162:163], v[106:107] neg_lo:[1,0,0] neg_hi:[1,0,0]
    v_pk_fma_f32 v[154:155], v[30:31], v[162:163], v[106:107]
    v_pk_fma_f32 v[42:43], v[30:31], v[166:167], v[110:111] neg_lo:[1,0,0] neg_hi:[1,0,0]
    v_pk_fma_f32 v[158:159], v[30:31], v[166:167], v[110:111]
    v_pk_mul_f32 v[162:163], v[34:35], v[162:163]
    v_pk_mul_f32 v[166:167], v[34:35], v[166:167]
    v_pk_add_f32 v[164:165], v[108:109], v[116:117] neg_lo:[0,1] neg_hi:[0,1]
    v_pk_add_f32 v[108:109], v[108:109], v[116:117]
    v_pk_add_f32 v[168:169], v[112:113], v[120:121] neg_lo:[0,1] neg_hi:[0,1]
    v_pk_add_f32 v[112:113], v[112:113], v[120:121]
    v_pk_fma_f32 v[40:41], v[32:33], v[164:165], v[108:109] neg_lo:[1,0,0] neg_hi:[1,0,0]
    v_pk_fma_f32 v[156:157], v[32:33], v[164:165], v[108:109]
    v_pk_fma_f32 v[44:45], v[32:33], v[168:169], v[112:113] neg_lo:[1,0,0] neg_hi:[1,0,0]
    v_pk_fma_f32 v[160:161], v[32:33], v[168:169], v[112:113]
    v_pk_mul_f32 v[164:165], v[36:37], v[164:165]
    v_pk_mul_f32 v[168:169], v[36:37], v[168:169]
    s_waitcnt vmcnt(0)
    v_bitop3_b32 v8, v50, v54, s60 bitop3:0x7e
    v_bitop3_b32 v9, v58, v62, s60 bitop3:0x7e
    v_or3_b32 v5, v8, v9, 0
    v_bitop3_b32 v8, v51, v55, s61 bitop3:0x7e
    v_bitop3_b32 v9, v59, v63, s61 bitop3:0x7e
    v_or3_b32 v5, v8, v9, v5
    v_bitop3_b32 v8, v52, v56, s62 bitop3:0x7e
    v_bitop3_b32 v9, v60, v64, s62 bitop3:0x7e
    v_or3_b32 v5, v8, v9, v5
    v_bitop3_b32 v8, v53, v57, s63 bitop3:0x7e
    v_bitop3_b32 v9, v61, v65, s63 bitop3:0x7e
    v_or3_b32 v5, v8, v9, v5
    v_and_b32 v5, 0x10001, v5
    v_cmp_ne_u32 vcc, 0, v5
    s_cbranch_vccnz Lre21
Lok20:
    s_xor_b32 s61, s61, 1
    v_mov_b32 v82, v50
    v_mov_b32 v83, v54
    v_mov_b32 v84, v58
    v_mov_b32 v85, v62
    ds_write_b128 v14, v[82:85] offset:16384
    v_mov_b32 v86, v51
    v_mov_b32 v87, v55
    v_mov_b32 v88, v59
    v_mov_b32 v89, v63
    ds_write_b128 v14, v[86:89] offset:17408
    v_mov_b32 v90, v52
    v_mov_b32 v91, v56
    v_mov_b32 v92, v60
    v_mov_b32 v93, v64
    ds_write_b128 v14, v[90:93] offset:18432
    v_mov_b32 v94, v53
    v_mov_b32 v95, v57
    v_mov_b32 v96, v61
    v_mov_b32 v97, v65
    ds_write_b128 v14, v[94:97] offset:19456
    s_waitcnt lgkmcnt(0)
    s_barrier
    ds_read_b128 v[82:85], v15 offset:16384
    ds_read_b128 v[86:89], v15 offset:17408
    ds_read_b128 v[90:93], v15 offset:18432
    ds_read_b128 v[94:97], v15 offset:19456
Ljs2:
    s_waitcnt lgkmcnt(3)
    v_mfma_f32_16x16x32_bf16 v[106:109], v[82:85], a[32:35], 0
    v_mfma_f32_16x16x32_bf16 v[130:133], v[82:85], a[36:39], 0
    s_waitcnt lgkmcnt(2)
    v_mfma_f32_16x16x32_bf16 v[110:113], v[86:89], a[32:35], 0
    v_mfma_f32_16x16x32_bf16 v[134:137], v[86:89], a[36:39], 0
    s_waitcnt lgkmcnt(1)
    v_mfma_f32_16x16x32_bf16 v[114:117], v[90:93], a[32:35], 0
    v_mfma_f32_16x16x32_bf16 v[138:141], v[90:93], a[36:39], 0
    s_waitcnt lgkmcnt(0)
    v_mfma_f32_16x16x32_bf16 v[118:121], v[94:97], a[32:35], 0
    v_mfma_f32_16x16x32_bf16 v[142:145], v[94:97], a[36:39], 0
    v_pk_mul_f32 v[194:195], v[106:107], v[22:23]
    v_pk_mul_f32 v[196:197], v[130:131], v[22:23]
    v_pk_mul_f32 v[198:199], v[108:109], v[24:25]
    v_pk_mul_f32 v[200:201], v[132:133], v[24:25]
    v_pk_fma_f32 v[194:195], v[130:131], v[26:27], v[194:195]
    v_pk_fma_f32 v[196:197], v[106:107], v[26:27], v[196:197] neg_lo:[1,0,0] neg_hi:[1,0,0]
    v_pk_fma_f32 v[198:199], v[132:133], v[28:29], v[198:199]
    v_pk_fma_f32 v[200:201], v[108:109], v[28:29], v[200:201] neg_lo:[1,0,0] neg_hi:[1,0,0]
    v_cvt_pk_bf16_f32 v82, v194, v196
    v_cvt_pk_bf16_f32 v83, v195, v197
    v_cvt_pk_bf16_f32 v84, v198, v200
    v_cvt_pk_bf16_f32 v85, v199, v201
    v_pk_mul_f32 v[194:195], v[110:111], v[22:23]
    v_pk_mul_f32 v[196:197], v[134:135], v[22:23]
    v_pk_mul_f32 v[198:199], v[112:113], v[24:25]
    v_pk_mul_f32 v[200:201], v[136:137], v[24:25]
    v_pk_fma_f32 v[194:195], v[134:135], v[26:27], v[194:195]
    v_pk_fma_f32 v[196:197], v[110:111], v[26:27], v[196:197] neg_lo:[1,0,0] neg_hi:[1,0,0]
    v_pk_fma_f32 v[198:199], v[136:137], v[28:29], v[198:199]
    v_pk_fma_f32 v[200:201], v[112:113], v[28:29], v[200:201] neg_lo:[1,0,0] neg_hi:[1,0,0]
    v_cvt_pk_bf16_f32 v86, v194, v196
    v_cvt_pk_bf16_f32 v87, v195, v197
    v_cvt_pk_bf16_f32 v88, v198, v200
    v_cvt_pk_bf16_f32 v89, v199, v201
    v_pk_mul_f32 v[194:195], v[114:115], v[22:23]
    v_pk_mul_f32 v[196:197], v[138:139], v[22:23]
    v_pk_mul_f32 v[198:199], v[116:117], v[24:25]
    v_pk_mul_f32 v[200:201], v[140:141], v[24:25]
    v_pk_fma_f32 v[194:195], v[138:139], v[26:27], v[194:195]
    v_pk_fma_f32 v[196:197], v[114:115], v[26:27], v[196:197] neg_lo:[1,0,0] neg_hi:[1,0,0]
    v_pk_fma_f32 v[198:199], v[140:141], v[28:29], v[198:199]
    v_pk_fma_f32 v[200:201], v[116:117], v[28:29], v[200:201] neg_lo:[1,0,0] neg_hi:[1,0,0]
    v_cvt_pk_bf16_f32 v90, v194, v196
    v_cvt_pk_bf16_f32 v91, v195, v197
    v_cvt_pk_bf16_f32 v92, v198, v200
    v_cvt_pk_bf16_f32 v93, v199, v201
    v_pk_mul_f32 v[194:195], v[118:119], v[22:23]
    v_pk_mul_f32 v[196:197], v[142:143], v[22:23]
    v_pk_mul_f32 v[198:199], v[120:121], v[24:25]
    v_pk_mul_f32 v[200:201], v[144:145], v[24:25]
    v_pk_fma_f32 v[194:195], v[142:143], v[26:27], v[194:195]
    v_pk_fma_f32 v[196:197], v[118:119], v[26:27], v[196:197] neg_lo:[1,0,0] neg_hi:[1,0,0]
    v_pk_fma_f32 v[198:199], v[144:145], v[28:29], v[198:199]
    v_pk_fma_f32 v[200:201], v[120:121], v[28:29], v[200:201] neg_lo:[1,0,0] neg_hi:[1,0,0]
    v_cvt_pk_bf16_f32 v94, v194, v196
    v_cvt_pk_bf16_f32 v95, v195, v197
    v_cvt_pk_bf16_f32 v96, v198, v200
    v_cvt_pk_bf16_f32 v97, v199, v201
    v_mfma_f32_16x16x32_bf16 v[106:109], a[32:35], v[82:85], 0
    v_mfma_f32_16x16x32_bf16 v[130:133], a[36:39], v[82:85], 0
    v_mfma_f32_16x16x32_bf16 v[110:113], a[32:35], v[86:89], 0
    v_mfma_f32_16x16x32_bf16 v[134:137], a[36:39], v[86:89], 0
    v_mfma_f32_16x16x32_bf16 v[114:117], a[32:35], v[90:93], 0
    v_mfma_f32_16x16x32_bf16 v[138:141], a[36:39], v[90:93], 0
    v_mfma_f32_16x16x32_bf16 v[118:121], a[32:35], v[94:97], 0
    v_mfma_f32_16x16x32_bf16 v[142:145], a[36:39], v[94:97], 0
    s_nop 0
    v_pk_mul_f32 v[194:195], v[38:39], v[106:107]
    v_pk_mul_f32 v[196:197], v[38:39], v[130:131]
    v_pk_mul_f32 v[198:199], v[154:155], v[110:111]
    v_pk_mul_f32 v[200:201], v[154:155], v[134:135]
    v_pk_fma_f32 v[194:195], v[42:43], v[130:131], v[194:195] neg_lo:[1,0,0] neg_hi:[1,0,0]
    v_pk_fma_f32 v[196:197], v[42:43], v[106:107], v[196:197]
    v_pk_fma_f32 v[198:199], v[158:159], v[134:135], v[198:199] neg_lo:[1,0,0] neg_hi:[1,0,0]
    v_pk_fma_f32 v[200:201], v[158:159], v[110:111], v[200:201]
    v_pk_fma_f32 v[194:195], v[166:167], v[110:111], v[194:195] neg_lo:[1,0,0] neg_hi:[1,0,0]
    v_pk_fma_f32 v[196:197], v[162:163], v[110:111], v[196:197]
    v_pk_fma_f32 v[198:199], v[162:163], v[130:131], v[198:199]
    v_pk_fma_f32 v[200:201], v[162:163], v[106:107], v[200:201] neg_lo:[1,0,0] neg_hi:[1,0,0]
    v_pk_fma_f32 v[194:195], v[162:163], v[134:135], v[194:195] neg_lo:[1,0,0] neg_hi:[1,0,0]
    v_pk_fma_f32 v[196:197], v[166:167], v[134:135], v[196:197] neg_lo:[1,0,0] neg_hi:[1,0,0]
    v_pk_fma_f32 v[198:199], v[166:167], v[106:107], v[198:199]
    v_pk_fma_f32 v[200:201], v[166:167], v[130:131], v[200:201]
    v_cvt_pk_bf16_f32 v82, v196, v194
    v_cvt_pk_bf16_f32 v86, v200, v198
    v_cvt_pk_bf16_f32 v83, v197, v195
    v_cvt_pk_bf16_f32 v87, v201, v199
    v_pk_mul_f32 v[194:195], v[40:41], v[108:109]
    v_pk_mul_f32 v[196:197], v[40:41], v[132:133]
    v_pk_mul_f32 v[198:199], v[156:157], v[112:113]
    v_pk_mul_f32 v[200:201], v[156:157], v[136:137]
    v_pk_fma_f32 v[194:195], v[44:45], v[132:133], v[194:195] neg_lo:[1,0,0] neg_hi:[1,0,0]
    v_pk_fma_f32 v[196:197], v[44:45], v[108:109], v[196:197]
    v_pk_fma_f32 v[198:199], v[160:161], v[136:137], v[198:199] neg_lo:[1,0,0] neg_hi:[1,0,0]
    v_pk_fma_f32 v[200:201], v[160:161], v[112:113], v[200:201]
    v_pk_fma_f32 v[194:195], v[168:169], v[112:113], v[194:195] neg_lo:[1,0,0] neg_hi:[1,0,0]
    v_pk_fma_f32 v[196:197], v[164:165], v[112:113], v[196:197]
    v_pk_fma_f32 v[198:199], v[164:165], v[132:133], v[198:199]
    v_pk_fma_f32 v[200:201], v[164:165], v[108:109], v[200:201] neg_lo:[1,0,0] neg_hi:[1,0,0]
    v_pk_fma_f32 v[194:195], v[164:165], v[136:137], v[194:195] neg_lo:[1,0,0] neg_hi:[1,0,0]
    v_pk_fma_f32 v[196:197], v[168:169], v[136:137], v[196:197] neg_lo:[1,0,0] neg_hi:[1,0,0]
    v_pk_fma_f32 v[198:199], v[168:169], v[108:109], v[198:199]
    v_pk_fma_f32 v[200:201], v[168:169], v[132:133], v[200:201]
    v_cvt_pk_bf16_f32 v84, v196, v194
    v_cvt_pk_bf16_f32 v88, v200, v198
    v_cvt_pk_bf16_f32 v85, v197, v195
    v_cvt_pk_bf16_f32 v89, v201, v199
Ljm3:
    s_not_b32 s37, s41
    v_mov_b32 v9, s37
    v_lshlrev_b32 v8, 2, v1
    s_lshl_b32 s36, s33, 7
    s_add_u32 s36, s36, 21168128
    s_cmp_eq_u32 s32, 0
    s_cselect_b64 exec, 0xffff, 0
    buffer_store_dword v9, v8, s[48:51], s36 offen sc1
    s_mov_b64 exec, -1
    v_pk_mul_f32 v[30:31], v[170:171], v[114:115]
    v_pk_mul_f32 v[32:33], v[170:171], v[138:139]
    v_pk_mul_f32 v[34:35], v[178:179], v[118:119]
    v_pk_mul_f32 v[36:37], v[178:179], v[142:143]
    v_pk_fma_f32 v[30:31], v[174:175], v[138:139], v[30:31] neg_lo:[1,0,0] neg_hi:[1,0,0]
    v_pk_fma_f32 v[32:33], v[174:175], v[114:115], v[32:33]
    v_pk_fma_f32 v[34:35], v[182:183], v[142:143], v[34:35] neg_lo:[1,0,0] neg_hi:[1,0,0]
    v_pk_fma_f32 v[36:37], v[182:183], v[118:119], v[36:37]
    v_pk_fma_f32 v[30:31], v[190:191], v[118:119], v[30:31] neg_lo:[1,0,0] neg_hi:[1,0,0]
    v_pk_fma_f32 v[32:33], v[186:187], v[118:119], v[32:33]
    v_pk_fma_f32 v[34:35], v[186:187], v[138:139], v[34:35]
    v_pk_fma_f32 v[36:37], v[186:187], v[114:115], v[36:37] neg_lo:[1,0,0] neg_hi:[1,0,0]
    v_pk_fma_f32 v[30:31], v[186:187], v[142:143], v[30:31] neg_lo:[1,0,0] neg_hi:[1,0,0]
    v_pk_fma_f32 v[32:33], v[190:191], v[142:143], v[32:33] neg_lo:[1,0,0] neg_hi:[1,0,0]
    v_pk_fma_f32 v[34:35], v[190:191], v[114:115], v[34:35]
    v_pk_fma_f32 v[36:37], v[190:191], v[138:139], v[36:37]
    v_cvt_pk_bf16_f32 v90, v32, v30
    v_cvt_pk_bf16_f32 v94, v36, v34
    v_cvt_pk_bf16_f32 v91, v33, v31
    v_cvt_pk_bf16_f32 v95, v37, v35
    v_pk_mul_f32 v[30:31], v[172:173], v[116:117]
    v_pk_mul_f32 v[32:33], v[172:173], v[140:141]
    v_pk_mul_f32 v[34:35], v[180:181], v[120:121]
    v_pk_mul_f32 v[36:37], v[180:181], v[144:145]
    v_pk_fma_f32 v[30:31], v[176:177], v[140:141], v[30:31] neg_lo:[1,0,0] neg_hi:[1,0,0]
    v_pk_fma_f32 v[32:33], v[176:177], v[116:117], v[32:33]
    v_pk_fma_f32 v[34:35], v[184:185], v[144:145], v[34:35] neg_lo:[1,0,0] neg_hi:[1,0,0]
    v_pk_fma_f32 v[36:37], v[184:185], v[120:121], v[36:37]
    v_pk_fma_f32 v[30:31], v[192:193], v[120:121], v[30:31] neg_lo:[1,0,0] neg_hi:[1,0,0]
    v_pk_fma_f32 v[32:33], v[188:189], v[120:121], v[32:33]
    v_pk_fma_f32 v[34:35], v[188:189], v[140:141], v[34:35]
    v_pk_fma_f32 v[36:37], v[188:189], v[116:117], v[36:37] neg_lo:[1,0,0] neg_hi:[1,0,0]
    v_pk_fma_f32 v[30:31], v[188:189], v[144:145], v[30:31] neg_lo:[1,0,0] neg_hi:[1,0,0]
    v_pk_fma_f32 v[32:33], v[192:193], v[144:145], v[32:33] neg_lo:[1,0,0] neg_hi:[1,0,0]
    v_pk_fma_f32 v[34:35], v[192:193], v[116:117], v[34:35]
    v_pk_fma_f32 v[36:37], v[192:193], v[140:141], v[36:37]
    v_cvt_pk_bf16_f32 v92, v32, v30
    v_cvt_pk_bf16_f32 v96, v36, v34
    v_cvt_pk_bf16_f32 v93, v33, v31
    v_cvt_pk_bf16_f32 v97, v37, v35
    v_mfma_f32_16x16x32_bf16 v[106:109], v[82:85], a[32:35], 0
    v_mfma_f32_16x16x32_bf16 v[130:133], v[82:85], a[36:39], 0
    v_mfma_f32_16x16x32_bf16 v[110:113], v[86:89], a[32:35], 0
    v_mfma_f32_16x16x32_bf16 v[134:137], v[86:89], a[36:39], 0
    v_mfma_f32_16x16x32_bf16 v[114:117], v[90:93], a[32:35], 0
    v_mfma_f32_16x16x32_bf16 v[138:141], v[90:93], a[36:39], 0
    v_mfma_f32_16x16x32_bf16 v[118:121], v[94:97], a[32:35], 0
    v_mfma_f32_16x16x32_bf16 v[142:145], v[94:97], a[36:39], 0
    s_nop 0
    v_pk_mul_f32 v[30:31], v[106:107], v[22:23]
    v_pk_mul_f32 v[32:33], v[130:131], v[22:23]
    v_pk_mul_f32 v[34:35], v[108:109], v[24:25]
    v_pk_mul_f32 v[36:37], v[132:133], v[24:25]
    v_pk_fma_f32 v[30:31], v[130:131], v[26:27], v[30:31]
    v_pk_fma_f32 v[32:33], v[106:107], v[26:27], v[32:33] neg_lo:[1,0,0] neg_hi:[1,0,0]
    v_pk_fma_f32 v[34:35], v[132:133], v[28:29], v[34:35]
    v_pk_fma_f32 v[36:37], v[108:109], v[28:29], v[36:37] neg_lo:[1,0,0] neg_hi:[1,0,0]
    v_cvt_pk_bf16_f32 v82, v30, v32
    v_cvt_pk_bf16_f32 v83, v31, v33
    v_cvt_pk_bf16_f32 v84, v34, v36
    v_cvt_pk_bf16_f32 v85, v35, v37
    v_pk_mul_f32 v[30:31], v[110:111], v[22:23]
    v_pk_mul_f32 v[32:33], v[134:135], v[22:23]
    v_pk_mul_f32 v[34:35], v[112:113], v[24:25]
    v_pk_mul_f32 v[36:37], v[136:137], v[24:25]
    v_pk_fma_f32 v[30:31], v[134:135], v[26:27], v[30:31]
    v_pk_fma_f32 v[32:33], v[110:111], v[26:27], v[32:33] neg_lo:[1,0,0] neg_hi:[1,0,0]
    v_pk_fma_f32 v[34:35], v[136:137], v[28:29], v[34:35]
    v_pk_fma_f32 v[36:37], v[112:113], v[28:29], v[36:37] neg_lo:[1,0,0] neg_hi:[1,0,0]
    v_cvt_pk_bf16_f32 v86, v30, v32
    v_cvt_pk_bf16_f32 v87, v31, v33
    v_cvt_pk_bf16_f32 v88, v34, v36
    v_cvt_pk_bf16_f32 v89, v35, v37
    v_pk_mul_f32 v[30:31], v[114:115], v[22:23]
    v_pk_mul_f32 v[32:33], v[138:139], v[22:23]
    v_pk_mul_f32 v[34:35], v[116:117], v[24:25]
    v_pk_mul_f32 v[36:37], v[140:141], v[24:25]
    v_pk_fma_f32 v[30:31], v[138:139], v[26:27], v[30:31]
    v_pk_fma_f32 v[32:33], v[114:115], v[26:27], v[32:33] neg_lo:[1,0,0] neg_hi:[1,0,0]
    v_pk_fma_f32 v[34:35], v[140:141], v[28:29], v[34:35]
    v_pk_fma_f32 v[36:37], v[116:117], v[28:29], v[36:37] neg_lo:[1,0,0] neg_hi:[1,0,0]
    v_cvt_pk_bf16_f32 v90, v30, v32
    v_cvt_pk_bf16_f32 v91, v31, v33
    v_cvt_pk_bf16_f32 v92, v34, v36
    v_cvt_pk_bf16_f32 v93, v35, v37
    v_pk_mul_f32 v[30:31], v[118:119], v[22:23]
    v_pk_mul_f32 v[32:33], v[142:143], v[22:23]
    v_pk_mul_f32 v[34:35], v[120:121], v[24:25]
    v_pk_mul_f32 v[36:37], v[144:145], v[24:25]
    v_pk_fma_f32 v[30:31], v[142:143], v[26:27], v[30:31]
    v_pk_fma_f32 v[32:33], v[118:119], v[26:27], v[32:33] neg_lo:[1,0,0] neg_hi:[1,0,0]
    v_pk_fma_f32 v[34:35], v[144:145], v[28:29], v[34:35]
    v_pk_fma_f32 v[36:37], v[120:121], v[28:29], v[36:37] neg_lo:[1,0,0] neg_hi:[1,0,0]
    v_cvt_pk_bf16_f32 v94, v30, v32
    v_cvt_pk_bf16_f32 v95, v31, v33
    v_cvt_pk_bf16_f32 v96, v34, v36
    v_cvt_pk_bf16_f32 v97, v35, v37
    v_mfma_f32_16x16x32_bf16 v[106:109], a[32:35], v[82:85], 0
    v_mfma_f32_16x16x32_bf16 v[130:133], a[36:39], v[82:85], 0
    v_mfma_f32_16x16x32_bf16 v[110:113], a[32:35], v[86:89], 0
    v_mfma_f32_16x16x32_bf16 v[134:137], a[36:39], v[86:89], 0
    v_mfma_f32_16x16x32_bf16 v[114:117], a[32:35], v[90:93], 0
    v_mfma_f32_16x16x32_bf16 v[138:141], a[36:39], v[90:93], 0
    v_mfma_f32_16x16x32_bf16 v[118:121], a[32:35], v[94:97], 0
    v_mfma_f32_16x16x32_bf16 v[142:145], a[36:39], v[94:97], 0
    s_nop 1
    v_cvt_pk_bf16_f32 v82, v130, v106
    s_nop 0
    v_cvt_pk_bf16_f32 v83, v134, v110
    s_nop 0
    v_cvt_pk_bf16_f32 v84, v138, v114
    s_nop 0
    v_cvt_pk_bf16_f32 v85, v142, v118
    v_bfi_b32 v82, v48, v82, s60
    v_bfi_b32 v83, v48, v83, s61
    v_bfi_b32 v84, v48, v84, s62
    v_bfi_b32 v85, v48, v85, s63
    ds_write_b128 v16, v[82:85] offset:34816
    v_cvt_pk_bf16_f32 v86, v131, v107
    v_cvt_pk_bf16_f32 v87, v135, v111
    v_cvt_pk_bf16_f32 v88, v139, v115
    v_cvt_pk_bf16_f32 v89, v143, v119
    v_bfi_b32 v86, v48, v86, s60
    v_bfi_b32 v87, v48, v87, s61
    v_bfi_b32 v88, v48, v88, s62
    v_bfi_b32 v89, v48, v89, s63
    ds_write_b128 v16, v[86:89] offset:35840
    v_cvt_pk_bf16_f32 v90, v132, v108
    v_cvt_pk_bf16_f32 v91, v136, v112
    v_cvt_pk_bf16_f32 v92, v140, v116
    v_cvt_pk_bf16_f32 v93, v144, v120
    v_bfi_b32 v90, v48, v90, s60
    v_bfi_b32 v91, v48, v91, s61
    v_bfi_b32 v92, v48, v92, s62
    v_bfi_b32 v93, v48, v93, s63
    ds_write_b128 v16, v[90:93] offset:36864
    v_cvt_pk_bf16_f32 v94, v133, v109
    v_cvt_pk_bf16_f32 v95, v137, v113
    v_cvt_pk_bf16_f32 v96, v141, v117
    v_cvt_pk_bf16_f32 v97, v145, v121
    v_bfi_b32 v94, v48, v94, s60
    v_bfi_b32 v95, v48, v95, s61
    v_bfi_b32 v96, v48, v96, s62
    v_bfi_b32 v97, v48, v97, s63
    ds_write_b128 v16, v[94:97] offset:37888
    s_waitcnt lgkmcnt(0)
    s_barrier
    ds_read_b128 v[106:109], v17 offset:34816
    ds_read_b128 v[110:113], v17 offset:35840
    ds_read_b128 v[114:117], v17 offset:36864
    ds_read_b128 v[118:121], v17 offset:37888
    s_waitcnt lgkmcnt(3)
    buffer_store_dwordx4 v[106:109], v18, s[48:51], s56 offen offset:0 sc1
    s_waitcnt lgkmcnt(2)
    buffer_store_dwordx4 v[110:113], v18, s[48:51], s56 offen offset:1024 sc1
    s_waitcnt lgkmcnt(1)
    buffer_store_dwordx4 v[114:117], v18, s[48:51], s56 offen offset:2048 sc1
    s_waitcnt lgkmcnt(0)
    buffer_store_dwordx4 v[118:121], v18, s[48:51], s56 offen offset:3072 sc1
    s_mov_b32 s37, 51200
    v_and_b32 v3, 15, v1
    v_lshrrev_b32 v4, 4, v1
    v_lshrrev_b32 v5, 5, v1
    v_bfe_u32 v7, v1, 2, 2
    v_and_b32 v8, 3, v1
    v_lshrrev_b32 v9, 2, v1
    v_bfe_u32 v10, v1, 4, 1
    v_lshlrev_b32 v7, 13, v5
    v_lshl_add_u32 v32, v10, 4, v3
    s_lshl_b32 s36, s32, 7
    v_lshl_add_u32 v32, v32, 1, s36
    v_lshrrev_b32 v29, 5, v32
    v_bfe_u32 v30, v32, 1, 3
    v_lshlrev_b32 v30, 2, v30
    v_xor_b32 v29, v29, v30
    v_and_b32 v30, 31, v32
    v_lshl_add_u32 v29, v30, 5, v29
    v_lshl_add_u32 v11, v29, 2, v7
    v_sub_u32 v31, 959, v32
    v_lshrrev_b32 v29, 5, v31
    v_bfe_u32 v30, v31, 1, 3
    v_lshlrev_b32 v30, 2, v30
    v_xor_b32 v29, v29, v30
    v_and_b32 v30, 31, v31
    v_lshl_add_u32 v29, v30, 5, v29
    v_lshl_add_u32 v12, v29, 2, v7
    v_sub_u32 v31, 960, v32
    v_lshrrev_b32 v29, 5, v31
    v_bfe_u32 v30, v31, 1, 3
    v_lshlrev_b32 v30, 2, v30
    v_xor_b32 v29, v29, v30
    v_and_b32 v30, 31, v31
    v_lshl_add_u32 v29, v30, 5, v29
    v_lshl_add_u32 v14, v29, 2, v7
    v_cmp_ne_u32 vcc, 0, v32
    v_sub_u32 v31, 0x400, v32
    v_mov_b32 v29, 0x200
    s_lshl_b32 s36, s32, 12
    v_cndmask_b32 v31, v29, v31, vcc
    v_lshrrev_b32 v29, 5, v31
    v_bfe_u32 v30, v31, 1, 3
    v_lshlrev_b32 v30, 2, v30
    v_xor_b32 v29, v29, v30
    v_and_b32 v30, 31, v31
    v_lshl_add_u32 v29, v30, 5, v29
    v_lshl_add_u32 v13, v29, 2, v7
    v_and_b32 v29, 31, v1
    v_bfe_u32 v30, v1, 1, 3
    v_xor_b32 v30, v30, v5
    v_lshl_add_u32 v30, v29, 3, v30
    v_lshl_add_u32 v15, v30, 4, s36
    v_xor_b32 v16, 32, v15
    v_xor_b32 v17, 64, v15
    v_xor_b32 v18, 0x60, v15
    v_add_u32 v21, s36, v2
    v_bfe_u32 v29, v1, 2, 1
    v_bfe_u32 v30, v1, 3, 1
    v_and_b32 v31, 0x13, v1
    v_lshl_or_b32 v31, v29, 3, v31
    v_lshl_or_b32 v31, v30, 2, v31
    v_bfe_u32 v32, v1, 1, 1
    v_lshl_or_b32 v32, v29, 1, v32
    v_xor_b32 v32, v32, v5
    v_lshl_add_u32 v32, v31, 2, v32
    v_lshl_add_u32 v19, v32, 4, s36
    v_xor_b32 v20, 32, v19
    v_lshl_or_b32 v30, v5, 1, v30
    v_xor_b32 v30, v30, v1
    v_lshlrev_b32 v22, 4, v30
    v_lshrrev_b32 v29, 3, v1
    v_and_b32 v30, 7, v1
    v_lshlrev_b32 v31, 4, v30
    v_lshl_add_u32 v27, v29, 14, v31
    v_lshl_add_u32 v28, v29, 12, v31
    v_xor_b32 v31, v30, v4
    s_lshl_b32 s36, s32, 11
    v_lshl_add_u32 v31, v31, 4, s36
    v_lshl_add_u32 v23, v29, 7, v31
    v_xor_b32 v24, 64, v23
    v_lshl_add_u32 v31, v30, 8, v31
    v_and_b32 v29, 8, v1
    v_add3_u32 v25, v31, v29, s37
    v_xor_b32 v26, 64, v25
    v_add_u32 v3, 8, v11
    v_add_u32 v4, 128, v11
    v_add_u32 v5, 136, v11
    v_add_u32 v7, 8, v12
    v_and_b32 v8, 0x13, v1
    v_bfe_u32 v9, v1, 2, 1
    v_lshl_or_b32 v8, v9, 3, v8
    v_bfe_u32 v9, v1, 3, 1
    v_lshl_or_b32 v8, v9, 2, v8
    v_lshrrev_b32 v9, 5, v1
    v_cvt_f32_u32 v8, v8
    v_cvt_f32_u32 v9, v9
    v_mul_f32 v8, 0x3a800000, v8
    v_mul_f32 v9, v9, v8
    v_mul_f32 v9, 4.0, v9
    v_fmamk_f32 v10, v8, 0x0, v9
    v_cos_f32 v30, v10
    v_sin_f32 v66, v10
    v_fmamk_f32 v10, v8, 0x3f800000, v9
    v_cos_f32 v31, v10
    v_sin_f32 v67, v10
    v_fmamk_f32 v10, v8, 0x40000000, v9
    v_cos_f32 v32, v10
    v_sin_f32 v68, v10
    v_fmamk_f32 v10, v8, 0x40400000, v9
    v_cos_f32 v33, v10
    v_sin_f32 v69, v10
    v_fmamk_f32 v10, v8, 0x41000000, v9
    v_cos_f32 v34, v10
    v_sin_f32 v70, v10
    v_fmamk_f32 v10, v8, 0x41100000, v9
    v_cos_f32 v35, v10
    v_sin_f32 v71, v10
    v_fmamk_f32 v10, v8, 0x41200000, v9
    v_cos_f32 v36, v10
    v_sin_f32 v72, v10
    v_fmamk_f32 v10, v8, 0x41300000, v9
    v_cos_f32 v37, v10
    v_sin_f32 v73, v10
    v_fmamk_f32 v10, v8, 0x41800000, v9
    v_cos_f32 v38, v10
    v_sin_f32 v74, v10
    v_fmamk_f32 v10, v8, 0x41880000, v9
    v_cos_f32 v39, v10
    v_sin_f32 v75, v10
    v_fmamk_f32 v10, v8, 0x41900000, v9
    v_cos_f32 v40, v10
    v_sin_f32 v76, v10
    v_fmamk_f32 v10, v8, 0x41980000, v9
    v_cos_f32 v41, v10
    v_sin_f32 v77, v10
    v_fmamk_f32 v10, v8, 0x41c00000, v9
    v_cos_f32 v42, v10
    v_sin_f32 v78, v10
    v_fmamk_f32 v10, v8, 0x41c80000, v9
    v_cos_f32 v43, v10
    v_sin_f32 v79, v10
    v_fmamk_f32 v10, v8, 0x41d00000, v9
    v_cos_f32 v44, v10
    v_sin_f32 v80, v10
    v_fmamk_f32 v10, v8, 0x41d80000, v9
    v_cos_f32 v45, v10
    v_sin_f32 v81, v10
    s_xor_b32 s53, s53, 1
    s_waitcnt vmcnt(0)
    s_sleep 24
    buffer_load_dwordx4 v[50:53], v6, s[48:51], s4 offen sc1
    buffer_load_dwordx4 v[54:57], v6, s[48:51], s5 offen sc1
    buffer_load_dwordx4 v[58:61], v6, s[48:51], s6 offen sc1
    buffer_load_dwordx4 v[62:65], v6, s[48:51], s7 offen sc1
    s_waitcnt vmcnt(0)
    v_bitop3_b32 v46, v50, v54, s60 bitop3:0x7e
    v_bitop3_b32 v47, v58, v62, s60 bitop3:0x7e
    v_or3_b32 v8, v46, v47, 0
    v_bitop3_b32 v46, v51, v55, s61 bitop3:0x7e
    v_bitop3_b32 v47, v59, v63, s61 bitop3:0x7e
    v_or3_b32 v8, v46, v47, v8
    v_bitop3_b32 v46, v52, v56, s62 bitop3:0x7e
    v_bitop3_b32 v47, v60, v64, s62 bitop3:0x7e
    v_or3_b32 v8, v46, v47, v8
    v_bitop3_b32 v46, v53, v57, s63 bitop3:0x7e
    v_bitop3_b32 v47, v61, v65, s63 bitop3:0x7e
    v_or3_b32 v8, v46, v47, v8
    v_and_b32 v8, 0x10001, v8
    v_cmp_ne_u32 vcc, 0, v8
    s_cbranch_vccnz Lre28
Lok27:
    v_mov_b32 v82, v50
    v_mov_b32 v83, v54
    v_mov_b32 v84, v58
    v_mov_b32 v85, v62
    v_mov_b32 v86, v51
    v_mov_b32 v87, v55
    v_mov_b32 v88, v59
    v_mov_b32 v89, v63
    v_mov_b32 v90, v52
    v_mov_b32 v91, v56
    v_mov_b32 v92, v60
    v_mov_b32 v93, v64
    v_mov_b32 v94, v53
    v_mov_b32 v95, v57
    v_mov_b32 v96, v61
    v_mov_b32 v97, v65
    v_mfma_f32_16x16x32_bf16 v[98:101], a[40:43], v[82:85], 0
    v_mfma_f32_16x16x32_bf16 v[114:117], a[44:47], v[82:85], 0
    v_mfma_f32_16x16x32_bf16 v[102:105], a[40:43], v[86:89], 0
    v_mfma_f32_16x16x32_bf16 v[118:121], a[44:47], v[86:89], 0
    v_mfma_f32_16x16x32_bf16 v[106:109], a[40:43], v[90:93], 0
    v_mfma_f32_16x16x32_bf16 v[122:125], a[44:47], v[90:93], 0
    v_mfma_f32_16x16x32_bf16 v[110:113], a[40:43], v[94:97], 0
    v_mfma_f32_16x16x32_bf16 v[126:129], a[44:47], v[94:97], 0
    s_nop 0
    v_cvt_pk_bf16_f32 v50, v99, v98
    v_cvt_pk_bf16_f32 v51, v101, v100
    v_cvt_pk_bf16_f32 v52, v115, v114
    v_cvt_pk_bf16_f32 v53, v117, v116
    ds_write2st64_b32 v11, v50, v51 offset0:64 offset1:80
    ds_write2st64_b32 v3, v52, v53 offset0:64 offset1:80
    v_cvt_pk_bf16_f32 v54, -v103, v102
    v_cvt_pk_bf16_f32 v55, -v105, v104
    v_cvt_pk_bf16_f32 v56, -v119, v118
    v_cvt_pk_bf16_f32 v57, -v121, v120
    ds_write2st64_b32 v13, v54, v55 offset0:64 offset1:80
    ds_write2st64_b32 v14, v56, v57 offset0:64 offset1:80
    v_cvt_pk_bf16_f32 v58, v107, v106
    v_cvt_pk_bf16_f32 v59, v109, v108
    v_cvt_pk_bf16_f32 v60, v123, v122
    v_cvt_pk_bf16_f32 v61, v125, v124
    ds_write2st64_b32 v4, v58, v59 offset0:64 offset1:80
    ds_write2st64_b32 v5, v60, v61 offset0:64 offset1:80
    v_cvt_pk_bf16_f32 v62, -v111, v110
    v_cvt_pk_bf16_f32 v63, -v113, v112
    v_cvt_pk_bf16_f32 v64, -v127, v126
    v_cvt_pk_bf16_f32 v65, -v129, v128
    ds_write2st64_b32 v7, v62, v63 offset0:64 offset1:80
    ds_write2st64_b32 v12, v64, v65 offset0:64 offset1:80
    s_waitcnt lgkmcnt(0)
    s_barrier
    ds_read_b128 v[82:85], v15 offset:16384
    ds_read_b128 v[86:89], v16 offset:16384
    ds_read_b128 v[90:93], v17 offset:16384
    ds_read_b128 v[94:97], v18 offset:16384
    s_waitcnt lgkmcnt(3)
    v_mfma_f32_32x32x16_bf16 v[98:113], v[82:85], a[0:3], 0
    v_mfma_f32_32x32x16_bf16 v[114:129], v[82:85], a[16:19], 0
    s_waitcnt lgkmcnt(2)
    v_mfma_f32_32x32x16_bf16 v[98:113], v[86:89], a[4:7], v[98:113]
    v_mfma_f32_32x32x16_bf16 v[114:129], v[86:89], a[20:23], v[114:129]
    s_waitcnt lgkmcnt(1)
    v_mfma_f32_32x32x16_bf16 v[98:113], v[90:93], a[8:11], v[98:113]
    v_mfma_f32_32x32x16_bf16 v[114:129], v[90:93], a[24:27], v[114:129]
    s_waitcnt lgkmcnt(0)
    v_mfma_f32_32x32x16_bf16 v[98:113], v[94:97], a[12:15], v[98:113]
    v_mfma_f32_32x32x16_bf16 v[114:129], v[94:97], a[28:31], v[114:129]
    s_nop 10
    v_pk_mul_f32 v[130:131], v[98:99], v[30:31]
    v_pk_mul_f32 v[132:133], v[114:115], v[30:31]
    v_pk_mul_f32 v[134:135], v[100:101], v[32:33]
    v_pk_mul_f32 v[136:137], v[116:117], v[32:33]
    v_pk_fma_f32 v[130:131], v[114:115], v[66:67], v[130:131]
    v_pk_fma_f32 v[132:133], v[98:99], v[66:67], v[132:133] neg_lo:[1,0,0] neg_hi:[1,0,0]
    v_pk_fma_f32 v[134:135], v[116:117], v[68:69], v[134:135]
    v_pk_fma_f32 v[136:137], v[100:101], v[68:69], v[136:137] neg_lo:[1,0,0] neg_hi:[1,0,0]
    v_cvt_pk_bf16_f32 v82, v130, v132
    v_cvt_pk_bf16_f32 v83, v131, v133
    v_cvt_pk_bf16_f32 v84, v134, v136
    v_cvt_pk_bf16_f32 v85, v135, v137
    v_pk_mul_f32 v[130:131], v[102:103], v[34:35]
    v_pk_mul_f32 v[132:133], v[118:119], v[34:35]
    v_pk_mul_f32 v[134:135], v[104:105], v[36:37]
    v_pk_mul_f32 v[136:137], v[120:121], v[36:37]
    v_pk_fma_f32 v[130:131], v[118:119], v[70:71], v[130:131]
    v_pk_fma_f32 v[132:133], v[102:103], v[70:71], v[132:133] neg_lo:[1,0,0] neg_hi:[1,0,0]
    v_pk_fma_f32 v[134:135], v[120:121], v[72:73], v[134:135]
    v_pk_fma_f32 v[136:137], v[104:105], v[72:73], v[136:137] neg_lo:[1,0,0] neg_hi:[1,0,0]
    v_cvt_pk_bf16_f32 v86, v130, v132
    v_cvt_pk_bf16_f32 v87, v131, v133
    v_cvt_pk_bf16_f32 v88, v134, v136
    v_cvt_pk_bf16_f32 v89, v135, v137
    v_pk_mul_f32 v[130:131], v[106:107], v[38:39]
    v_pk_mul_f32 v[132:133], v[122:123], v[38:39]
    v_pk_mul_f32 v[134:135], v[108:109], v[40:41]
    v_pk_mul_f32 v[136:137], v[124:125], v[40:41]
    v_pk_fma_f32 v[130:131], v[122:123], v[74:75], v[130:131]
    v_pk_fma_f32 v[132:133], v[106:107], v[74:75], v[132:133] neg_lo:[1,0,0] neg_hi:[1,0,0]
    v_pk_fma_f32 v[134:135], v[124:125], v[76:77], v[134:135]
    v_pk_fma_f32 v[136:137], v[108:109], v[76:77], v[136:137] neg_lo:[1,0,0] neg_hi:[1,0,0]
    v_cvt_pk_bf16_f32 v90, v130, v132
    v_cvt_pk_bf16_f32 v91, v131, v133
    v_cvt_pk_bf16_f32 v92, v134, v136
    v_cvt_pk_bf16_f32 v93, v135, v137
    v_pk_mul_f32 v[130:131], v[110:111], v[42:43]
    v_pk_mul_f32 v[132:133], v[126:127], v[42:43]
    v_pk_mul_f32 v[134:135], v[112:113], v[44:45]
    v_pk_mul_f32 v[136:137], v[128:129], v[44:45]
    v_pk_fma_f32 v[130:131], v[126:127], v[78:79], v[130:131]
    v_pk_fma_f32 v[132:133], v[110:111], v[78:79], v[132:133] neg_lo:[1,0,0] neg_hi:[1,0,0]
    v_pk_fma_f32 v[134:135], v[128:129], v[80:81], v[134:135]
    v_pk_fma_f32 v[136:137], v[112:113], v[80:81], v[136:137] neg_lo:[1,0,0] neg_hi:[1,0,0]
    v_cvt_pk_bf16_f32 v94, v130, v132
    v_cvt_pk_bf16_f32 v95, v131, v133
    v_cvt_pk_bf16_f32 v96, v134, v136
    v_cvt_pk_bf16_f32 v97, v135, v137
    v_mfma_f32_32x32x16_bf16 v[98:113], v[82:85], a[0:3], 0
    v_mfma_f32_32x32x16_bf16 v[114:129], v[82:85], a[16:19], 0
    v_mfma_f32_32x32x16_bf16 v[98:113], v[86:89], a[4:7], v[98:113]
    v_mfma_f32_32x32x16_bf16 v[114:129], v[86:89], a[20:23], v[114:129]
    v_mfma_f32_32x32x16_bf16 v[98:113], v[90:93], a[8:11], v[98:113]
    v_mfma_f32_32x32x16_bf16 v[114:129], v[90:93], a[24:27], v[114:129]
    v_mfma_f32_32x32x16_bf16 v[98:113], v[94:97], a[12:15], v[98:113]
    v_mfma_f32_32x32x16_bf16 v[114:129], v[94:97], a[28:31], v[114:129]
    s_nop 11
    v_cvt_pk_bf16_f32 v82, v114, v115
    v_cvt_pk_bf16_f32 v83, v116, v117
    v_cvt_pk_bf16_f32 v84, v118, v119
    v_cvt_pk_bf16_f32 v85, v120, v121
    ds_write_b128 v19, v[82:85] offset:16384
    v_cvt_pk_bf16_f32 v86, v122, v123
    v_cvt_pk_bf16_f32 v87, v124, v125
    v_cvt_pk_bf16_f32 v88, v126, v127
    v_cvt_pk_bf16_f32 v89, v128, v129
    ds_write_b128 v20, v[86:89] offset:16384
    v_cvt_pk_bf16_f32 v90, v98, v99
    v_cvt_pk_bf16_f32 v91, v100, v101
    v_cvt_pk_bf16_f32 v92, v102, v103
    v_cvt_pk_bf16_f32 v93, v104, v105
    ds_write_b128 v19, v[90:93] offset:18432
    v_cvt_pk_bf16_f32 v94, v106, v107
    v_cvt_pk_bf16_f32 v95, v108, v109
    v_cvt_pk_bf16_f32 v96, v110, v111
    v_cvt_pk_bf16_f32 v97, v112, v113
    ds_write_b128 v20, v[94:97] offset:18432
    ds_read_b128 v[98:101], v21 offset:16384
    ds_read_b128 v[102:105], v21 offset:17408
    ds_read_b128 v[106:109], v21 offset:18432
    ds_read_b128 v[110:113], v21 offset:19456
    s_waitcnt lgkmcnt(3)
    buffer_store_dwordx4 v[98:101], v22, s[68:71], s9 offen offset:0 sc1
    s_waitcnt lgkmcnt(2)
    buffer_store_dwordx4 v[102:105], v22, s[68:71], s9 offen offset:1024 sc1
    s_waitcnt lgkmcnt(1)
    buffer_store_dwordx4 v[106:109], v22, s[68:71], s10 offen offset:0 sc1
    s_waitcnt lgkmcnt(0)
    buffer_store_dwordx4 v[110:113], v22, s[68:71], s10 offen offset:1024 sc1
    s_sleep 16
    s_add_u32 s12, s8, 0
    s_add_u32 s13, s8, 131072
    buffer_load_dwordx4 v[82:85], v27, s[48:51], s12 offen sc1
    buffer_load_dwordx4 v[86:89], v27, s[48:51], s13 offen sc1
    s_add_u32 s14, s8, 8192
    s_add_u32 s15, s8, 139264
    buffer_load_dwordx4 v[90:93], v27, s[48:51], s14 offen sc1
    buffer_load_dwordx4 v[94:97], v27, s[48:51], s15 offen sc1
    s_waitcnt vmcnt(2)
    v_bitop3_b32 v8, v82, v86, s52 bitop3:0x7e
    v_bitop3_b32 v47, v83, v87, s53 bitop3:0x7e
    v_bitop3_b32 v46, v84, v88, s54 bitop3:0x7e
    v_or3_b32 v8, v8, v46, v47
    v_bitop3_b32 v47, v85, v89, s55 bitop3:0x7e
    v_or_b32 v8, v8, v47
    v_and_b32 v8, 0x10001, v8
    v_cmp_ne_u32 vcc, 0, v8
    s_cbranch_vccnz Lre35
Lok34:
    s_or_b32 s36, s45, s32
    s_cmp_eq_u32 s36, 0
    s_cbranch_scc1 Lepo40
Lep39:
    ds_write_b128 v23, v[82:85] offset:51200
    ds_write_b128 v24, v[86:89] offset:52224
    ds_read2_b64 v[82:85], v25 offset0:0 offset1:16
    ds_read2_b64 v[86:89], v26 offset0:0 offset1:16
    s_add_u32 s36, s11, 0
    s_waitcnt lgkmcnt(1)
    buffer_store_dwordx4 v[82:85], v28, s[68:71], s36 offen sc1
    s_add_u32 s36, s11, 32768
    s_waitcnt lgkmcnt(0)
    buffer_store_dwordx4 v[86:89], v28, s[68:71], s36 offen sc1
    s_waitcnt vmcnt(2)
    v_bitop3_b32 v8, v90, v94, s52 bitop3:0x7e
    v_bitop3_b32 v47, v91, v95, s53 bitop3:0x7e
    v_bitop3_b32 v46, v92, v96, s54 bitop3:0x7e
    v_or3_b32 v8, v8, v46, v47
    v_bitop3_b32 v47, v93, v97, s55 bitop3:0x7e
    v_or_b32 v8, v8, v47
    v_and_b32 v8, 0x10001, v8
    v_cmp_ne_u32 vcc, 0, v8
    s_cbranch_vccnz Lre42
Lok41:
    ds_write_b128 v23, v[90:93] offset:51200
    ds_write_b128 v24, v[94:97] offset:52224
    ds_read2_b64 v[90:93], v25 offset0:0 offset1:16
    ds_read2_b64 v[94:97], v26 offset0:0 offset1:16
    s_add_u32 s36, s11, 4194304
    s_waitcnt lgkmcnt(1)
    buffer_store_dwordx4 v[90:93], v28, s[68:71], s36 offen sc1
    s_add_u32 s36, s11, 4227072
    s_waitcnt lgkmcnt(0)
    buffer_store_dwordx4 v[94:97], v28, s[68:71], s36 offen sc1
    s_endpgm
L_B:
    s_cmp_ge_u32 s2, 512
    s_cbranch_scc1 L_end
    s_sub_u32 s2, s2, 256
    s_getpc_b64 s[38:39]
L_pcB:
    s_load_dwordx16 s[4:19], s[0:1], 0
    s_lshr_b32 s36, s2, 3
    v_lshrrev_b32 v3, 6, v0
    v_and_b32 v1, 63, v0
    v_readfirstlane_b32 s32, v3
    s_load_dwordx8 s[20:27], s[0:1], 64
    s_load_dwordx2 s[28:29], s[0:1], 96
    s_load_dwordx2 s[30:31], s[0:1], 112
    v_lshlrev_b32 v2, 4, v1
    s_and_b32 s33, s2, 7
    s_lshl_b32 s33, s33, 5
    s_add_u32 s33, s33, s36
    s_lshl2_add_u32 s44, s33, s32
    s_waitcnt lgkmcnt(0)
    s_lshl_b32 s37, s44, 8
    v_lshl_add_u32 v5, v1, 2, s37
    s_lshr_b32 s37, s44, 1
    s_lshl_b32 s37, s37, 2
    s_load_dword s47, s[24:25], s37
    s_load_dword s48, s[26:27], s37
    global_load_dword v6, v5, s[12:13]
    global_load_dword v7, v5, s[14:15]
    global_load_dword v8, v5, s[16:17]
    global_load_dword v9, v5, s[18:19]
    global_load_dword v10, v5, s[20:21]
    global_load_dword v11, v5, s[22:23]
    s_add_u32 s42, s30, 21102592
    s_addc_u32 s43, s31, 0
    s_lshr_b32 s46, s33, 4
    s_lshl_b32 s36, s46, 7
    s_add_u32 s36, s36, 256
    s_load_dword s41, s[42:43], s36
    s_lshr_b32 s34, s33, 6
    s_and_b32 s35, s33, 63
    s_and_b32 s45, s33, 15
    s_mul_i32 s49, s32, 20384
    v_and_b32 v12, 15, v1
    v_lshrrev_b32 v13, 4, v1
    v_mad_u32_u24 v12, v12, 33, v13
    v_lshl_add_u32 v3, v12, 4, s49
    v_and_b32 v12, 31, v1
    v_lshl_add_u32 v5, v12, 4, s49
    v_mov_b32 v12, 0
    v_mov_b32 v13, 0
    v_mov_b32 v14, 0
    v_mov_b32 v15, 0
    ds_write_b128 v5, v[12:15]
    s_mov_b32 s52, s30
    s_mov_b32 s53, s31
    s_mov_b32 s54, 268435456
    s_mov_b32 s55, 0x20000
    s_lshl_b32 s50, s33, 14
    s_lshl_b32 s36, s32, 12
    s_add_u32 s50, s50, s36
    s_add_u32 s50, s50, 8388608
    s_lshl_b32 s51, s33, 14
    s_lshl_b32 s36, s32, 11
    s_add_u32 s51, s51, s36
    s_add_u32 s51, s51, 8388608
    s_add_u32 s56, s51, 8192
    s_waitcnt lgkmcnt(0)
    s_not_b32 s8, s41
    s_mul_i32 s36, s41, 0x9e3779b1
    s_lshr_b32 s37, s36, 15
    s_and_b32 s5, s37, 0x10001
    s_lshr_b32 s37, s36, 14
    s_and_b32 s6, s37, 0x10001
    s_lshr_b32 s37, s36, 13
    s_and_b32 s7, s37, 0x10001
    s_lshr_b32 s37, s36, 12
    s_and_b32 s37, s37, 0x10000
    s_and_b32 s4, s8, 1
    s_or_b32 s4, s4, s37
    v_mov_b32 v12, 0xfffefffe
    s_and_b32 s36, s44, 1
    s_lshl_b32 s36, s36, 4
    s_lshr_b32 s47, s47, s36
    s_lshl_b32 s47, s47, 16
    s_lshr_b32 s48, s48, s36
    s_lshl_b32 s48, s48, 16
    v_mov_b32 v46, 0x3fb8aa3b
    v_mul_f32 v47, s47, v46
    v_fma_f32 v48, s47, v46, -v47
    v_mov_b32 v46, 0x32a57060
    v_exp_f32 v13, v47
    v_fmac_f32 v48, s47, v46
    v_mul_f32 v48, 0x3f317218, v48
    v_fmac_f32 v13, v13, v48
    v_cvt_pk_bf16_f32 v13, v13, v13
    v_lshlrev_b32 v13, 16, v13
    s_mov_b32 m0, s49
    s_waitcnt vmcnt(0)
    v_lshlrev_b32 v30, 16, v8
    v_lshlrev_b32 v31, 16, v9
    v_lshlrev_b32 v26, 16, v10
    v_lshlrev_b32 v27, 16, v11
    v_mul_f32 v30, v13, v30
    v_mul_f32 v31, v13, v31
    v_and_b32 v32, 0xffff0000, v8
    v_and_b32 v33, 0xffff0000, v9
    v_and_b32 v28, 0xffff0000, v10
    v_and_b32 v29, 0xffff0000, v11
    v_mul_f32 v32, v13, v32
    v_mul_f32 v33, v13, v33
    v_pk_mul_f32 v[34:35], v[26:27], v[30:31] op_sel:[0,0] op_sel_hi:[0,1]
    v_pk_mul_f32 v[36:37], v[28:29], v[32:33] op_sel:[0,0] op_sel_hi:[0,1]
    v_pk_fma_f32 v[26:27], v[26:27], v[30:31], v[34:35] op_sel:[1,1,0] op_sel_hi:[1,0,1] neg_lo:[0,1,0]
    v_pk_fma_f32 v[28:29], v[28:29], v[32:33], v[36:37] op_sel:[1,1,0] op_sel_hi:[1,0,1] neg_lo:[0,1,0]
    v_lshlrev_b32 v50, 16, v6
    v_lshlrev_b32 v51, 16, v7
    v_mul_f32 v50, v13, v50
    v_mul_f32 v51, v13, v51
    v_mul_f32 v50, 0x3fb8aa3b, v50
    v_mul_f32 v51, 0x3e22f983, v51
    v_and_b32 v52, 0xffff0000, v6
    v_and_b32 v53, 0xffff0000, v7
    v_mul_f32 v52, v13, v52
    v_mul_f32 v53, v13, v53
    v_mul_f32 v52, 0x3fb8aa3b, v52
    v_mul_f32 v53, 0x3e22f983, v53
    v_exp_f32 v46, v50
    v_fract_f32 v47, v51
    v_cos_f32 v14, v47
    v_sin_f32 v15, v47
    v_mul_f32 v14, v46, v14
    v_mul_f32 v15, v46, v15
    v_exp_f32 v46, v52
    v_fract_f32 v47, v53
    v_cos_f32 v16, v47
    v_sin_f32 v17, v47
    v_mul_f32 v16, v46, v16
    v_mul_f32 v17, v46, v17
    v_mul_f32 v46, 0x41000000, v50
    v_mul_f32 v47, 0x41000000, v51
    v_exp_f32 v46, v46
    v_fract_f32 v47, v47
    v_cos_f32 v18, v47
    v_sin_f32 v19, v47
    v_mul_f32 v18, v46, v18
    v_mul_f32 v19, v46, v19
    v_mul_f32 v46, 0x41000000, v52
    v_mul_f32 v47, 0x41000000, v53
    v_exp_f32 v46, v46
    v_fract_f32 v47, v47
    v_cos_f32 v20, v47
    v_sin_f32 v21, v47
    v_mul_f32 v20, v46, v20
    v_mul_f32 v21, v46, v21
    v_mul_f32 v46, 0x43000000, v50
    v_mul_f32 v47, 0x43000000, v51
    v_exp_f32 v46, v46
    v_fract_f32 v47, v47
    v_cos_f32 v22, v47
    v_sin_f32 v23, v47
    v_mul_f32 v22, v46, v22
    v_mul_f32 v23, v46, v23
    v_mul_f32 v46, 0x43000000, v52
    v_mul_f32 v47, 0x43000000, v53
    v_exp_f32 v46, v46
    v_fract_f32 v47, v47
    v_cos_f32 v24, v47
    v_sin_f32 v25, v47
    v_mul_f32 v24, v46, v24
    v_mul_f32 v25, v46, v25
    v_mov_b32 v38, 0x3f80
    v_mov_b32 v39, 0x3f80
    v_cvt_pk_bf16_f32 v40, v18, -v19
    v_cvt_pk_bf16_f32 v41, v20, -v21
    v_pk_mul_f32 v[34:35], v[18:19], v[18:19] op_sel:[0,0] op_sel_hi:[0,1]
    v_pk_mul_f32 v[36:37], v[20:21], v[20:21] op_sel:[0,0] op_sel_hi:[0,1]
    v_pk_fma_f32 v[30:31], v[18:19], v[18:19], v[34:35] op_sel:[1,1,0] op_sel_hi:[1,0,1] neg_lo:[0,1,0]
    v_pk_fma_f32 v[32:33], v[20:21], v[20:21], v[36:37] op_sel:[1,1,0] op_sel_hi:[1,0,1] neg_lo:[0,1,0]
    v_cvt_pk_bf16_f32 v42, v30, -v31
    v_cvt_pk_bf16_f32 v43, v32, -v33
    v_pk_mul_f32 v[34:35], v[30:31], v[18:19] op_sel:[0,0] op_sel_hi:[0,1]
    v_pk_mul_f32 v[36:37], v[32:33], v[20:21] op_sel:[0,0] op_sel_hi:[0,1]
    v_pk_fma_f32 v[30:31], v[30:31], v[18:19], v[34:35] op_sel:[1,1,0] op_sel_hi:[1,0,1] neg_lo:[0,1,0]
    v_pk_fma_f32 v[32:33], v[32:33], v[20:21], v[36:37] op_sel:[1,1,0] op_sel_hi:[1,0,1] neg_lo:[0,1,0]
    v_cvt_pk_bf16_f32 v44, v30, -v31
    v_cvt_pk_bf16_f32 v45, v32, -v33
    ds_write_addtid_b32 v38 offset:256
    ds_write_addtid_b32 v39 offset:512
    ds_write_addtid_b32 v40 offset:784
    ds_write_addtid_b32 v41 offset:1040
    ds_write_addtid_b32 v42 offset:1312
    ds_write_addtid_b32 v43 offset:1568
    ds_write_addtid_b32 v44 offset:1840
    ds_write_addtid_b32 v45 offset:2096
    v_pk_mul_f32 v[34:35], v[30:31], v[18:19] op_sel:[0,0] op_sel_hi:[0,1]
    v_pk_mul_f32 v[36:37], v[32:33], v[20:21] op_sel:[0,0] op_sel_hi:[0,1]
    v_pk_fma_f32 v[30:31], v[30:31], v[18:19], v[34:35] op_sel:[1,1,0] op_sel_hi:[1,0,1] neg_lo:[0,1,0]
    v_pk_fma_f32 v[32:33], v[32:33], v[20:21], v[36:37] op_sel:[1,1,0] op_sel_hi:[1,0,1] neg_lo:[0,1,0]
    v_cvt_pk_bf16_f32 v38, v30, -v31
    v_cvt_pk_bf16_f32 v39, v32, -v33
    v_pk_mul_f32 v[34:35], v[30:31], v[18:19] op_sel:[0,0] op_sel_hi:[0,1]
    v_pk_mul_f32 v[36:37], v[32:33], v[20:21] op_sel:[0,0] op_sel_hi:[0,1]
    v_pk_fma_f32 v[30:31], v[30:31], v[18:19], v[34:35] op_sel:[1,1,0] op_sel_hi:[1,0,1] neg_lo:[0,1,0]
    v_pk_fma_f32 v[32:33], v[32:33], v[20:21], v[36:37] op_sel:[1,1,0] op_sel_hi:[1,0,1] neg_lo:[0,1,0]
    v_cvt_pk_bf16_f32 v40, v30, -v31
    v_cvt_pk_bf16_f32 v41, v32, -v33
    v_pk_mul_f32 v[34:35], v[30:31], v[18:19] op_sel:[0,0] op_sel_hi:[0,1]
    v_pk_mul_f32 v[36:37], v[32:33], v[20:21] op_sel:[0,0] op_sel_hi:[0,1]
    v_pk_fma_f32 v[30:31], v[30:31], v[18:19], v[34:35] op_sel:[1,1,0] op_sel_hi:[1,0,1] neg_lo:[0,1,0]
    v_pk_fma_f32 v[32:33], v[32:33], v[20:21], v[36:37] op_sel:[1,1,0] op_sel_hi:[1,0,1] neg_lo:[0,1,0]
    v_cvt_pk_bf16_f32 v42, v30, -v31
    v_cvt_pk_bf16_f32 v43, v32, -v33
    v_pk_mul_f32 v[34:35], v[30:31], v[18:19] op_sel:[0,0] op_sel_hi:[0,1]
    v_pk_mul_f32 v[36:37], v[32:33], v[20:21] op_sel:[0,0] op_sel_hi:[0,1]
    v_pk_fma_f32 v[30:31], v[30:31], v[18:19], v[34:35] op_sel:[1,1,0] op_sel_hi:[1,0,1] neg_lo:[0,1,0]
    v_pk_fma_f32 v[32:33], v[32:33], v[20:21], v[36:37] op_sel:[1,1,0] op_sel_hi:[1,0,1] neg_lo:[0,1,0]
    v_cvt_pk_bf16_f32 v44, v30, -v31
    v_cvt_pk_bf16_f32 v45, v32, -v33
    ds_write_addtid_b32 v38 offset:2368
    ds_write_addtid_b32 v39 offset:2624
    ds_write_addtid_b32 v40 offset:2896
    ds_write_addtid_b32 v41 offset:3152
    ds_write_addtid_b32 v42 offset:3424
    ds_write_addtid_b32 v43 offset:3680
    ds_write_addtid_b32 v44 offset:3952
    ds_write_addtid_b32 v45 offset:4208
    v_pk_mul_f32 v[34:35], v[30:31], v[18:19] op_sel:[0,0] op_sel_hi:[0,1]
    v_pk_mul_f32 v[36:37], v[32:33], v[20:21] op_sel:[0,0] op_sel_hi:[0,1]
    v_pk_fma_f32 v[30:31], v[30:31], v[18:19], v[34:35] op_sel:[1,1,0] op_sel_hi:[1,0,1] neg_lo:[0,1,0]
    v_pk_fma_f32 v[32:33], v[32:33], v[20:21], v[36:37] op_sel:[1,1,0] op_sel_hi:[1,0,1] neg_lo:[0,1,0]
    v_cvt_pk_bf16_f32 v38, v30, -v31
    v_cvt_pk_bf16_f32 v39, v32, -v33
    v_pk_mul_f32 v[34:35], v[30:31], v[18:19] op_sel:[0,0] op_sel_hi:[0,1]
    v_pk_mul_f32 v[36:37], v[32:33], v[20:21] op_sel:[0,0] op_sel_hi:[0,1]
    v_pk_fma_f32 v[30:31], v[30:31], v[18:19], v[34:35] op_sel:[1,1,0] op_sel_hi:[1,0,1] neg_lo:[0,1,0]
    v_pk_fma_f32 v[32:33], v[32:33], v[20:21], v[36:37] op_sel:[1,1,0] op_sel_hi:[1,0,1] neg_lo:[0,1,0]
    v_cvt_pk_bf16_f32 v40, v30, -v31
    v_cvt_pk_bf16_f32 v41, v32, -v33
    v_pk_mul_f32 v[34:35], v[30:31], v[18:19] op_sel:[0,0] op_sel_hi:[0,1]
    v_pk_mul_f32 v[36:37], v[32:33], v[20:21] op_sel:[0,0] op_sel_hi:[0,1]
    v_pk_fma_f32 v[30:31], v[30:31], v[18:19], v[34:35] op_sel:[1,1,0] op_sel_hi:[1,0,1] neg_lo:[0,1,0]
    v_pk_fma_f32 v[32:33], v[32:33], v[20:21], v[36:37] op_sel:[1,1,0] op_sel_hi:[1,0,1] neg_lo:[0,1,0]
    v_cvt_pk_bf16_f32 v42, v30, -v31
    v_cvt_pk_bf16_f32 v43, v32, -v33
    v_pk_mul_f32 v[34:35], v[30:31], v[18:19] op_sel:[0,0] op_sel_hi:[0,1]
    v_pk_mul_f32 v[36:37], v[32:33], v[20:21] op_sel:[0,0] op_sel_hi:[0,1]
    v_pk_fma_f32 v[30:31], v[30:31], v[18:19], v[34:35] op_sel:[1,1,0] op_sel_hi:[1,0,1] neg_lo:[0,1,0]
    v_pk_fma_f32 v[32:33], v[32:33], v[20:21], v[36:37] op_sel:[1,1,0] op_sel_hi:[1,0,1] neg_lo:[0,1,0]
    v_cvt_pk_bf16_f32 v44, v30, -v31
    v_cvt_pk_bf16_f32 v45, v32, -v33
    ds_write_addtid_b32 v38 offset:4480
    ds_write_addtid_b32 v39 offset:4736
    ds_write_addtid_b32 v40 offset:5008
    ds_write_addtid_b32 v41 offset:5264
    ds_write_addtid_b32 v42 offset:5536
    ds_write_addtid_b32 v43 offset:5792
    ds_write_addtid_b32 v44 offset:6064
    ds_write_addtid_b32 v45 offset:6320
    v_pk_mul_f32 v[34:35], v[30:31], v[18:19] op_sel:[0,0] op_sel_hi:[0,1]
    v_pk_mul_f32 v[36:37], v[32:33], v[20:21] op_sel:[0,0] op_sel_hi:[0,1]
    v_pk_fma_f32 v[30:31], v[30:31], v[18:19], v[34:35] op_sel:[1,1,0] op_sel_hi:[1,0,1] neg_lo:[0,1,0]
    v_pk_fma_f32 v[32:33], v[32:33], v[20:21], v[36:37] op_sel:[1,1,0] op_sel_hi:[1,0,1] neg_lo:[0,1,0]
    v_cvt_pk_bf16_f32 v38, v30, -v31
    v_cvt_pk_bf16_f32 v39, v32, -v33
    v_pk_mul_f32 v[34:35], v[30:31], v[18:19] op_sel:[0,0] op_sel_hi:[0,1]
    v_pk_mul_f32 v[36:37], v[32:33], v[20:21] op_sel:[0,0] op_sel_hi:[0,1]
    v_pk_fma_f32 v[30:31], v[30:31], v[18:19], v[34:35] op_sel:[1,1,0] op_sel_hi:[1,0,1] neg_lo:[0,1,0]
    v_pk_fma_f32 v[32:33], v[32:33], v[20:21], v[36:37] op_sel:[1,1,0] op_sel_hi:[1,0,1] neg_lo:[0,1,0]
    v_cvt_pk_bf16_f32 v40, v30, -v31
    v_cvt_pk_bf16_f32 v41, v32, -v33
    v_pk_mul_f32 v[34:35], v[30:31], v[18:19] op_sel:[0,0] op_sel_hi:[0,1]
    v_pk_mul_f32 v[36:37], v[32:33], v[20:21] op_sel:[0,0] op_sel_hi:[0,1]
    v_pk_fma_f32 v[30:31], v[30:31], v[18:19], v[34:35] op_sel:[1,1,0] op_sel_hi:[1,0,1] neg_lo:[0,1,0]
    v_pk_fma_f32 v[32:33], v[32:33], v[20:21], v[36:37] op_sel:[1,1,0] op_sel_hi:[1,0,1] neg_lo:[0,1,0]
    v_cvt_pk_bf16_f32 v42, v30, -v31
    v_cvt_pk_bf16_f32 v43, v32, -v33
    v_pk_mul_f32 v[34:35], v[30:31], v[18:19] op_sel:[0,0] op_sel_hi:[0,1]
    v_pk_mul_f32 v[36:37], v[32:33], v[20:21] op_sel:[0,0] op_sel_hi:[0,1]
    v_pk_fma_f32 v[30:31], v[30:31], v[18:19], v[34:35] op_sel:[1,1,0] op_sel_hi:[1,0,1] neg_lo:[0,1,0]
    v_pk_fma_f32 v[32:33], v[32:33], v[20:21], v[36:37] op_sel:[1,1,0] op_sel_hi:[1,0,1] neg_lo:[0,1,0]
    v_cvt_pk_bf16_f32 v44, v30, -v31
    v_cvt_pk_bf16_f32 v45, v32, -v33
    ds_write_addtid_b32 v38 offset:6592
    ds_write_addtid_b32 v39 offset:6848
    ds_write_addtid_b32 v40 offset:7120
    ds_write_addtid_b32 v41 offset:7376
    ds_write_addtid_b32 v42 offset:7648
    ds_write_addtid_b32 v43 offset:7904
    ds_write_addtid_b32 v44 offset:8176
    ds_write_addtid_b32 v45 offset:8432
    v_cvt_pk_bf16_f32 v38, v26, v27
    v_cvt_pk_bf16_f32 v39, v28, v29
    v_pk_mul_f32 v[34:35], v[26:27], v[14:15] op_sel:[0,0] op_sel_hi:[0,1]
    v_pk_mul_f32 v[36:37], v[28:29], v[16:17] op_sel:[0,0] op_sel_hi:[0,1]
    v_pk_fma_f32 v[30:31], v[26:27], v[14:15], v[34:35] op_sel:[1,1,0] op_sel_hi:[1,0,1] neg_lo:[0,1,0]
    v_pk_fma_f32 v[32:33], v[28:29], v[16:17], v[36:37] op_sel:[1,1,0] op_sel_hi:[1,0,1] neg_lo:[0,1,0]
    v_cvt_pk_bf16_f32 v40, v30, v31
    v_cvt_pk_bf16_f32 v41, v32, v33
    v_pk_mul_f32 v[34:35], v[30:31], v[14:15] op_sel:[0,0] op_sel_hi:[0,1]
    v_pk_mul_f32 v[36:37], v[32:33], v[16:17] op_sel:[0,0] op_sel_hi:[0,1]
    v_pk_fma_f32 v[30:31], v[30:31], v[14:15], v[34:35] op_sel:[1,1,0] op_sel_hi:[1,0,1] neg_lo:[0,1,0]
    v_pk_fma_f32 v[32:33], v[32:33], v[16:17], v[36:37] op_sel:[1,1,0] op_sel_hi:[1,0,1] neg_lo:[0,1,0]
    v_cvt_pk_bf16_f32 v42, v30, v31
    v_cvt_pk_bf16_f32 v43, v32, v33
    v_pk_mul_f32 v[34:35], v[30:31], v[14:15] op_sel:[0,0] op_sel_hi:[0,1]
    v_pk_mul_f32 v[36:37], v[32:33], v[16:17] op_sel:[0,0] op_sel_hi:[0,1]
    v_pk_fma_f32 v[30:31], v[30:31], v[14:15], v[34:35] op_sel:[1,1,0] op_sel_hi:[1,0,1] neg_lo:[0,1,0]
    v_pk_fma_f32 v[32:33], v[32:33], v[16:17], v[36:37] op_sel:[1,1,0] op_sel_hi:[1,0,1] neg_lo:[0,1,0]
    v_cvt_pk_bf16_f32 v44, v30, v31
    v_cvt_pk_bf16_f32 v45, v32, v33
    ds_write_addtid_b32 v38 offset:8704
    ds_write_addtid_b32 v39 offset:8960
    ds_write_addtid_b32 v40 offset:9232
    ds_write_addtid_b32 v41 offset:9488
    ds_write_addtid_b32 v42 offset:9760
    ds_write_addtid_b32 v43 offset:10016
    ds_write_addtid_b32 v44 offset:10288
    ds_write_addtid_b32 v45 offset:10544
    v_pk_mul_f32 v[34:35], v[30:31], v[14:15] op_sel:[0,0] op_sel_hi:[0,1]
    v_pk_mul_f32 v[36:37], v[32:33], v[16:17] op_sel:[0,0] op_sel_hi:[0,1]
    v_pk_fma_f32 v[30:31], v[30:31], v[14:15], v[34:35] op_sel:[1,1,0] op_sel_hi:[1,0,1] neg_lo:[0,1,0]
    v_pk_fma_f32 v[32:33], v[32:33], v[16:17], v[36:37] op_sel:[1,1,0] op_sel_hi:[1,0,1] neg_lo:[0,1,0]
    v_cvt_pk_bf16_f32 v38, v30, v31
    v_cvt_pk_bf16_f32 v39, v32, v33
    v_pk_mul_f32 v[34:35], v[30:31], v[14:15] op_sel:[0,0] op_sel_hi:[0,1]
    v_pk_mul_f32 v[36:37], v[32:33], v[16:17] op_sel:[0,0] op_sel_hi:[0,1]
    v_pk_fma_f32 v[30:31], v[30:31], v[14:15], v[34:35] op_sel:[1,1,0] op_sel_hi:[1,0,1] neg_lo:[0,1,0]
    v_pk_fma_f32 v[32:33], v[32:33], v[16:17], v[36:37] op_sel:[1,1,0] op_sel_hi:[1,0,1] neg_lo:[0,1,0]
    v_cvt_pk_bf16_f32 v40, v30, v31
    v_cvt_pk_bf16_f32 v41, v32, v33
    v_pk_mul_f32 v[34:35], v[30:31], v[14:15] op_sel:[0,0] op_sel_hi:[0,1]
    v_pk_mul_f32 v[36:37], v[32:33], v[16:17] op_sel:[0,0] op_sel_hi:[0,1]
    v_pk_fma_f32 v[30:31], v[30:31], v[14:15], v[34:35] op_sel:[1,1,0] op_sel_hi:[1,0,1] neg_lo:[0,1,0]
    v_pk_fma_f32 v[32:33], v[32:33], v[16:17], v[36:37] op_sel:[1,1,0] op_sel_hi:[1,0,1] neg_lo:[0,1,0]
    v_cvt_pk_bf16_f32 v42, v30, v31
    v_cvt_pk_bf16_f32 v43, v32, v33
    v_pk_mul_f32 v[34:35], v[30:31], v[14:15] op_sel:[0,0] op_sel_hi:[0,1]
    v_pk_mul_f32 v[36:37], v[32:33], v[16:17] op_sel:[0,0] op_sel_hi:[0,1]
    v_pk_fma_f32 v[30:31], v[30:31], v[14:15], v[34:35] op_sel:[1,1,0] op_sel_hi:[1,0,1] neg_lo:[0,1,0]
    v_pk_fma_f32 v[32:33], v[32:33], v[16:17], v[36:37] op_sel:[1,1,0] op_sel_hi:[1,0,1] neg_lo:[0,1,0]
    v_cvt_pk_bf16_f32 v44, v30, v31
    v_cvt_pk_bf16_f32 v45, v32, v33
    ds_write_addtid_b32 v38 offset:10816
    ds_write_addtid_b32 v39 offset:11072
    ds_write_addtid_b32 v40 offset:11344
    ds_write_addtid_b32 v41 offset:11600
    ds_write_addtid_b32 v42 offset:11872
    ds_write_addtid_b32 v43 offset:12128
    ds_write_addtid_b32 v44 offset:12400
    ds_write_addtid_b32 v45 offset:12656
    v_pk_mul_f32 v[34:35], v[26:27], v[22:23] op_sel:[0,0] op_sel_hi:[0,1]
    v_pk_mul_f32 v[36:37], v[28:29], v[24:25] op_sel:[0,0] op_sel_hi:[0,1]
    v_pk_fma_f32 v[26:27], v[26:27], v[22:23], v[34:35] op_sel:[1,1,0] op_sel_hi:[1,0,1] neg_lo:[0,1,0]
    v_pk_fma_f32 v[28:29], v[28:29], v[24:25], v[36:37] op_sel:[1,1,0] op_sel_hi:[1,0,1] neg_lo:[0,1,0]
    v_cvt_pk_bf16_f32 v38, v26, v27
    v_cvt_pk_bf16_f32 v39, v28, v29
    v_pk_mul_f32 v[34:35], v[26:27], v[14:15] op_sel:[0,0] op_sel_hi:[0,1]
    v_pk_mul_f32 v[36:37], v[28:29], v[16:17] op_sel:[0,0] op_sel_hi:[0,1]
    v_pk_fma_f32 v[30:31], v[26:27], v[14:15], v[34:35] op_sel:[1,1,0] op_sel_hi:[1,0,1] neg_lo:[0,1,0]
    v_pk_fma_f32 v[32:33], v[28:29], v[16:17], v[36:37] op_sel:[1,1,0] op_sel_hi:[1,0,1] neg_lo:[0,1,0]
    v_cvt_pk_bf16_f32 v40, v30, v31
    v_cvt_pk_bf16_f32 v41, v32, v33
    v_pk_mul_f32 v[34:35], v[30:31], v[14:15] op_sel:[0,0] op_sel_hi:[0,1]
    v_pk_mul_f32 v[36:37], v[32:33], v[16:17] op_sel:[0,0] op_sel_hi:[0,1]
    v_pk_fma_f32 v[30:31], v[30:31], v[14:15], v[34:35] op_sel:[1,1,0] op_sel_hi:[1,0,1] neg_lo:[0,1,0]
    v_pk_fma_f32 v[32:33], v[32:33], v[16:17], v[36:37] op_sel:[1,1,0] op_sel_hi:[1,0,1] neg_lo:[0,1,0]
    v_cvt_pk_bf16_f32 v42, v30, v31
    v_cvt_pk_bf16_f32 v43, v32, v33
    v_pk_mul_f32 v[34:35], v[30:31], v[14:15] op_sel:[0,0] op_sel_hi:[0,1]
    v_pk_mul_f32 v[36:37], v[32:33], v[16:17] op_sel:[0,0] op_sel_hi:[0,1]
    v_pk_fma_f32 v[30:31], v[30:31], v[14:15], v[34:35] op_sel:[1,1,0] op_sel_hi:[1,0,1] neg_lo:[0,1,0]
    v_pk_fma_f32 v[32:33], v[32:33], v[16:17], v[36:37] op_sel:[1,1,0] op_sel_hi:[1,0,1] neg_lo:[0,1,0]
    v_cvt_pk_bf16_f32 v44, v30, v31
    v_cvt_pk_bf16_f32 v45, v32, v33
    ds_write_addtid_b32 v38 offset:12928
    ds_write_addtid_b32 v39 offset:13184
    ds_write_addtid_b32 v40 offset:13456
    ds_write_addtid_b32 v41 offset:13712
    ds_write_addtid_b32 v42 offset:13984
    ds_write_addtid_b32 v43 offset:14240
    ds_write_addtid_b32 v44 offset:14512
    ds_write_addtid_b32 v45 offset:14768
    v_pk_mul_f32 v[34:35], v[30:31], v[14:15] op_sel:[0,0] op_sel_hi:[0,1]
    v_pk_mul_f32 v[36:37], v[32:33], v[16:17] op_sel:[0,0] op_sel_hi:[0,1]
    v_pk_fma_f32 v[30:31], v[30:31], v[14:15], v[34:35] op_sel:[1,1,0] op_sel_hi:[1,0,1] neg_lo:[0,1,0]
    v_pk_fma_f32 v[32:33], v[32:33], v[16:17], v[36:37] op_sel:[1,1,0] op_sel_hi:[1,0,1] neg_lo:[0,1,0]
    v_cvt_pk_bf16_f32 v38, v30, v31
    v_cvt_pk_bf16_f32 v39, v32, v33
    v_pk_mul_f32 v[34:35], v[30:31], v[14:15] op_sel:[0,0] op_sel_hi:[0,1]
    v_pk_mul_f32 v[36:37], v[32:33], v[16:17] op_sel:[0,0] op_sel_hi:[0,1]
    v_pk_fma_f32 v[30:31], v[30:31], v[14:15], v[34:35] op_sel:[1,1,0] op_sel_hi:[1,0,1] neg_lo:[0,1,0]
    v_pk_fma_f32 v[32:33], v[32:33], v[16:17], v[36:37] op_sel:[1,1,0] op_sel_hi:[1,0,1] neg_lo:[0,1,0]
    v_cvt_pk_bf16_f32 v40, v30, v31
    v_cvt_pk_bf16_f32 v41, v32, v33
    v_pk_mul_f32 v[34:35], v[30:31], v[14:15] op_sel:[0,0] op_sel_hi:[0,1]
    v_pk_mul_f32 v[36:37], v[32:33], v[16:17] op_sel:[0,0] op_sel_hi:[0,1]
    v_pk_fma_f32 v[30:31], v[30:31], v[14:15], v[34:35] op_sel:[1,1,0] op_sel_hi:[1,0,1] neg_lo:[0,1,0]
    v_pk_fma_f32 v[32:33], v[32:33], v[16:17], v[36:37] op_sel:[1,1,0] op_sel_hi:[1,0,1] neg_lo:[0,1,0]
    v_cvt_pk_bf16_f32 v42, v30, v31
    v_cvt_pk_bf16_f32 v43, v32, v33
    v_pk_mul_f32 v[34:35], v[30:31], v[14:15] op_sel:[0,0] op_sel_hi:[0,1]
    v_pk_mul_f32 v[36:37], v[32:33], v[16:17] op_sel:[0,0] op_sel_hi:[0,1]
    v_pk_fma_f32 v[30:31], v[30:31], v[14:15], v[34:35] op_sel:[1,1,0] op_sel_hi:[1,0,1] neg_lo:[0,1,0]
    v_pk_fma_f32 v[32:33], v[32:33], v[16:17], v[36:37] op_sel:[1,1,0] op_sel_hi:[1,0,1] neg_lo:[0,1,0]
    v_cvt_pk_bf16_f32 v44, v30, v31
    v_cvt_pk_bf16_f32 v45, v32, v33
    ds_write_addtid_b32 v38 offset:15040
    ds_write_addtid_b32 v39 offset:15296
    ds_write_addtid_b32 v40 offset:15568
    ds_write_addtid_b32 v41 offset:15824
    ds_write_addtid_b32 v42 offset:16096
    ds_write_addtid_b32 v43 offset:16352
    ds_write_addtid_b32 v44 offset:16624
    ds_write_addtid_b32 v45 offset:16880
    ds_read_b128 a[0:3], v3 offset:256
    ds_read_b128 v[46:49], v3 offset:8704
    ds_read_b128 a[4:7], v3 offset:320
    ds_read_b128 v[50:53], v3 offset:8768
    ds_read_b128 a[8:11], v3 offset:384
    ds_read_b128 v[54:57], v3 offset:8832
    ds_read_b128 a[12:15], v3 offset:448
    ds_read_b128 v[58:61], v3 offset:8896
    ds_read_b128 a[16:19], v3 offset:512
    ds_read_b128 v[62:65], v3 offset:8960
    ds_read_b128 a[20:23], v3 offset:576
    ds_read_b128 v[66:69], v3 offset:9024
    ds_read_b128 a[24:27], v3 offset:640
    ds_read_b128 v[70:73], v3 offset:9088
    ds_read_b128 a[28:31], v3 offset:704
    ds_read_b128 v[74:77], v3 offset:9152
    v_pk_mul_f32 v[34:35], v[14:15], v[14:15] op_sel:[0,0] op_sel_hi:[0,1]
    v_pk_mul_f32 v[36:37], v[16:17], v[16:17] op_sel:[0,0] op_sel_hi:[0,1]
    v_pk_fma_f32 v[14:15], v[14:15], v[14:15], v[34:35] op_sel:[1,1,0] op_sel_hi:[1,0,1] neg_lo:[0,1,0]
    v_pk_fma_f32 v[16:17], v[16:17], v[16:17], v[36:37] op_sel:[1,1,0] op_sel_hi:[1,0,1] neg_lo:[0,1,0]
    v_pk_mul_f32 v[34:35], v[14:15], v[14:15] op_sel:[0,0] op_sel_hi:[0,1]
    v_pk_mul_f32 v[36:37], v[16:17], v[16:17] op_sel:[0,0] op_sel_hi:[0,1]
    v_pk_fma_f32 v[18:19], v[14:15], v[14:15], v[34:35] op_sel:[1,1,0] op_sel_hi:[1,0,1] neg_lo:[0,1,0]
    v_pk_fma_f32 v[20:21], v[16:17], v[16:17], v[36:37] op_sel:[1,1,0] op_sel_hi:[1,0,1] neg_lo:[0,1,0]
    v_pk_mul_f32 v[34:35], v[26:27], v[22:23] op_sel:[0,0] op_sel_hi:[0,1]
    v_pk_mul_f32 v[36:37], v[28:29], v[24:25] op_sel:[0,0] op_sel_hi:[0,1]
    v_pk_fma_f32 v[26:27], v[26:27], v[22:23], v[34:35] op_sel:[1,1,0] op_sel_hi:[1,0,1] neg_lo:[0,1,0]
    v_pk_fma_f32 v[28:29], v[28:29], v[24:25], v[36:37] op_sel:[1,1,0] op_sel_hi:[1,0,1] neg_lo:[0,1,0]
    v_cvt_pk_bf16_f32 v38, v26, v27
    v_cvt_pk_bf16_f32 v39, v28, v29
    v_pk_mul_f32 v[34:35], v[26:27], v[14:15] op_sel:[0,0] op_sel_hi:[0,1]
    v_pk_mul_f32 v[36:37], v[28:29], v[16:17] op_sel:[0,0] op_sel_hi:[0,1]
    v_pk_fma_f32 v[30:31], v[26:27], v[14:15], v[34:35] op_sel:[1,1,0] op_sel_hi:[1,0,1] neg_lo:[0,1,0]
    v_pk_fma_f32 v[32:33], v[28:29], v[16:17], v[36:37] op_sel:[1,1,0] op_sel_hi:[1,0,1] neg_lo:[0,1,0]
    v_cvt_pk_bf16_f32 v40, v30, v31
    v_cvt_pk_bf16_f32 v41, v32, v33
    v_pk_mul_f32 v[34:35], v[30:31], v[14:15] op_sel:[0,0] op_sel_hi:[0,1]
    v_pk_mul_f32 v[36:37], v[32:33], v[16:17] op_sel:[0,0] op_sel_hi:[0,1]
    v_pk_fma_f32 v[30:31], v[30:31], v[14:15], v[34:35] op_sel:[1,1,0] op_sel_hi:[1,0,1] neg_lo:[0,1,0]
    v_pk_fma_f32 v[32:33], v[32:33], v[16:17], v[36:37] op_sel:[1,1,0] op_sel_hi:[1,0,1] neg_lo:[0,1,0]
    v_cvt_pk_bf16_f32 v42, v30, v31
    v_cvt_pk_bf16_f32 v43, v32, v33
    v_pk_mul_f32 v[34:35], v[30:31], v[14:15] op_sel:[0,0] op_sel_hi:[0,1]
    v_pk_mul_f32 v[36:37], v[32:33], v[16:17] op_sel:[0,0] op_sel_hi:[0,1]
    v_pk_fma_f32 v[30:31], v[30:31], v[14:15], v[34:35] op_sel:[1,1,0] op_sel_hi:[1,0,1] neg_lo:[0,1,0]
    v_pk_fma_f32 v[32:33], v[32:33], v[16:17], v[36:37] op_sel:[1,1,0] op_sel_hi:[1,0,1] neg_lo:[0,1,0]
    v_cvt_pk_bf16_f32 v44, v30, v31
    v_cvt_pk_bf16_f32 v45, v32, v33
    ds_write_addtid_b32 v38 offset:256
    ds_write_addtid_b32 v39 offset:512
    ds_write_addtid_b32 v40 offset:784
    ds_write_addtid_b32 v41 offset:1040
    ds_write_addtid_b32 v42 offset:1312
    ds_write_addtid_b32 v43 offset:1568
    ds_write_addtid_b32 v44 offset:1840
    ds_write_addtid_b32 v45 offset:2096
    v_pk_mul_f32 v[34:35], v[26:27], v[22:23] op_sel:[0,0] op_sel_hi:[0,1]
    v_pk_mul_f32 v[36:37], v[28:29], v[24:25] op_sel:[0,0] op_sel_hi:[0,1]
    v_pk_fma_f32 v[26:27], v[26:27], v[22:23], v[34:35] op_sel:[1,1,0] op_sel_hi:[1,0,1] neg_lo:[0,1,0]
    v_pk_fma_f32 v[28:29], v[28:29], v[24:25], v[36:37] op_sel:[1,1,0] op_sel_hi:[1,0,1] neg_lo:[0,1,0]
    v_cvt_pk_bf16_f32 v38, v26, v27
    v_cvt_pk_bf16_f32 v39, v28, v29
    v_pk_mul_f32 v[34:35], v[26:27], v[14:15] op_sel:[0,0] op_sel_hi:[0,1]
    v_pk_mul_f32 v[36:37], v[28:29], v[16:17] op_sel:[0,0] op_sel_hi:[0,1]
    v_pk_fma_f32 v[30:31], v[26:27], v[14:15], v[34:35] op_sel:[1,1,0] op_sel_hi:[1,0,1] neg_lo:[0,1,0]
    v_pk_fma_f32 v[32:33], v[28:29], v[16:17], v[36:37] op_sel:[1,1,0] op_sel_hi:[1,0,1] neg_lo:[0,1,0]
    v_cvt_pk_bf16_f32 v40, v30, v31
    v_cvt_pk_bf16_f32 v41, v32, v33
    v_pk_mul_f32 v[34:35], v[30:31], v[14:15] op_sel:[0,0] op_sel_hi:[0,1]
    v_pk_mul_f32 v[36:37], v[32:33], v[16:17] op_sel:[0,0] op_sel_hi:[0,1]
    v_pk_fma_f32 v[30:31], v[30:31], v[14:15], v[34:35] op_sel:[1,1,0] op_sel_hi:[1,0,1] neg_lo:[0,1,0]
    v_pk_fma_f32 v[32:33], v[32:33], v[16:17], v[36:37] op_sel:[1,1,0] op_sel_hi:[1,0,1] neg_lo:[0,1,0]
    v_cvt_pk_bf16_f32 v42, v30, v31
    v_cvt_pk_bf16_f32 v43, v32, v33
    v_pk_mul_f32 v[34:35], v[30:31], v[14:15] op_sel:[0,0] op_sel_hi:[0,1]
    v_pk_mul_f32 v[36:37], v[32:33], v[16:17] op_sel:[0,0] op_sel_hi:[0,1]
    v_pk_fma_f32 v[30:31], v[30:31], v[14:15], v[34:35] op_sel:[1,1,0] op_sel_hi:[1,0,1] neg_lo:[0,1,0]
    v_pk_fma_f32 v[32:33], v[32:33], v[16:17], v[36:37] op_sel:[1,1,0] op_sel_hi:[1,0,1] neg_lo:[0,1,0]
    v_cvt_pk_bf16_f32 v44, v30, v31
    v_cvt_pk_bf16_f32 v45, v32, v33
    ds_write_addtid_b32 v38 offset:2368
    ds_write_addtid_b32 v39 offset:2624
    ds_write_addtid_b32 v40 offset:2896
    ds_write_addtid_b32 v41 offset:3152
    ds_write_addtid_b32 v42 offset:3424
    ds_write_addtid_b32 v43 offset:3680
    ds_write_addtid_b32 v44 offset:3952
    ds_write_addtid_b32 v45 offset:4208
    v_pk_mul_f32 v[34:35], v[26:27], v[22:23] op_sel:[0,0] op_sel_hi:[0,1]
    v_pk_mul_f32 v[36:37], v[28:29], v[24:25] op_sel:[0,0] op_sel_hi:[0,1]
    v_pk_fma_f32 v[26:27], v[26:27], v[22:23], v[34:35] op_sel:[1,1,0] op_sel_hi:[1,0,1] neg_lo:[0,1,0]
    v_pk_fma_f32 v[28:29], v[28:29], v[24:25], v[36:37] op_sel:[1,1,0] op_sel_hi:[1,0,1] neg_lo:[0,1,0]
    v_cvt_pk_bf16_f32 v38, v26, v27
    v_cvt_pk_bf16_f32 v39, v28, v29
    v_pk_mul_f32 v[34:35], v[26:27], v[18:19] op_sel:[0,0] op_sel_hi:[0,1]
    v_pk_mul_f32 v[36:37], v[28:29], v[20:21] op_sel:[0,0] op_sel_hi:[0,1]
    v_pk_fma_f32 v[30:31], v[26:27], v[18:19], v[34:35] op_sel:[1,1,0] op_sel_hi:[1,0,1] neg_lo:[0,1,0]
    v_pk_fma_f32 v[32:33], v[28:29], v[20:21], v[36:37] op_sel:[1,1,0] op_sel_hi:[1,0,1] neg_lo:[0,1,0]
    v_cvt_pk_bf16_f32 v40, v30, v31
    v_cvt_pk_bf16_f32 v41, v32, v33
    v_pk_mul_f32 v[34:35], v[26:27], v[22:23] op_sel:[0,0] op_sel_hi:[0,1]
    v_pk_mul_f32 v[36:37], v[28:29], v[24:25] op_sel:[0,0] op_sel_hi:[0,1]
    v_pk_fma_f32 v[26:27], v[26:27], v[22:23], v[34:35] op_sel:[1,1,0] op_sel_hi:[1,0,1] neg_lo:[0,1,0]
    v_pk_fma_f32 v[28:29], v[28:29], v[24:25], v[36:37] op_sel:[1,1,0] op_sel_hi:[1,0,1] neg_lo:[0,1,0]
    v_cvt_pk_bf16_f32 v42, v26, v27
    v_cvt_pk_bf16_f32 v43, v28, v29
    v_pk_mul_f32 v[34:35], v[26:27], v[18:19] op_sel:[0,0] op_sel_hi:[0,1]
    v_pk_mul_f32 v[36:37], v[28:29], v[20:21] op_sel:[0,0] op_sel_hi:[0,1]
    v_pk_fma_f32 v[30:31], v[26:27], v[18:19], v[34:35] op_sel:[1,1,0] op_sel_hi:[1,0,1] neg_lo:[0,1,0]
    v_pk_fma_f32 v[32:33], v[28:29], v[20:21], v[36:37] op_sel:[1,1,0] op_sel_hi:[1,0,1] neg_lo:[0,1,0]
    v_cvt_pk_bf16_f32 v44, v30, v31
    v_cvt_pk_bf16_f32 v45, v32, v33
    ds_write_addtid_b32 v38 offset:4480
    ds_write_addtid_b32 v39 offset:4736
    ds_write_addtid_b32 v40 offset:5008
    ds_write_addtid_b32 v41 offset:5264
    ds_write_addtid_b32 v42 offset:5536
    ds_write_addtid_b32 v43 offset:5792
    ds_write_addtid_b32 v44 offset:6064
    ds_write_addtid_b32 v45 offset:6320
    v_pk_mul_f32 v[34:35], v[26:27], v[22:23] op_sel:[0,0] op_sel_hi:[0,1]
    v_pk_mul_f32 v[36:37], v[28:29], v[24:25] op_sel:[0,0] op_sel_hi:[0,1]
    v_pk_fma_f32 v[26:27], v[26:27], v[22:23], v[34:35] op_sel:[1,1,0] op_sel_hi:[1,0,1] neg_lo:[0,1,0]
    v_pk_fma_f32 v[28:29], v[28:29], v[24:25], v[36:37] op_sel:[1,1,0] op_sel_hi:[1,0,1] neg_lo:[0,1,0]
    v_cvt_pk_bf16_f32 v38, v26, v27
    v_cvt_pk_bf16_f32 v39, v28, v29
    v_pk_mul_f32 v[34:35], v[26:27], v[18:19] op_sel:[0,0] op_sel_hi:[0,1]
    v_pk_mul_f32 v[36:37], v[28:29], v[20:21] op_sel:[0,0] op_sel_hi:[0,1]
    v_pk_fma_f32 v[30:31], v[26:27], v[18:19], v[34:35] op_sel:[1,1,0] op_sel_hi:[1,0,1] neg_lo:[0,1,0]
    v_pk_fma_f32 v[32:33], v[28:29], v[20:21], v[36:37] op_sel:[1,1,0] op_sel_hi:[1,0,1] neg_lo:[0,1,0]
    v_cvt_pk_bf16_f32 v40, v30, v31
    v_cvt_pk_bf16_f32 v41, v32, v33
    v_pk_mul_f32 v[34:35], v[26:27], v[22:23] op_sel:[0,0] op_sel_hi:[0,1]
    v_pk_mul_f32 v[36:37], v[28:29], v[24:25] op_sel:[0,0] op_sel_hi:[0,1]
    v_pk_fma_f32 v[26:27], v[26:27], v[22:23], v[34:35] op_sel:[1,1,0] op_sel_hi:[1,0,1] neg_lo:[0,1,0]
    v_pk_fma_f32 v[28:29], v[28:29], v[24:25], v[36:37] op_sel:[1,1,0] op_sel_hi:[1,0,1] neg_lo:[0,1,0]
    v_cvt_pk_bf16_f32 v42, v26, v27
    v_cvt_pk_bf16_f32 v43, v28, v29
    v_pk_mul_f32 v[34:35], v[26:27], v[18:19] op_sel:[0,0] op_sel_hi:[0,1]
    v_pk_mul_f32 v[36:37], v[28:29], v[20:21] op_sel:[0,0] op_sel_hi:[0,1]
    v_pk_fma_f32 v[30:31], v[26:27], v[18:19], v[34:35] op_sel:[1,1,0] op_sel_hi:[1,0,1] neg_lo:[0,1,0]
    v_pk_fma_f32 v[32:33], v[28:29], v[20:21], v[36:37] op_sel:[1,1,0] op_sel_hi:[1,0,1] neg_lo:[0,1,0]
    v_cvt_pk_bf16_f32 v44, v30, v31
    v_cvt_pk_bf16_f32 v45, v32, v33
    ds_write_addtid_b32 v38 offset:6592
    ds_write_addtid_b32 v39 offset:6848
    ds_write_addtid_b32 v40 offset:7120
    ds_write_addtid_b32 v41 offset:7376
    ds_write_addtid_b32 v42 offset:7648
    ds_write_addtid_b32 v43 offset:7904
    ds_write_addtid_b32 v44 offset:8176
    ds_write_addtid_b32 v45 offset:8432
    v_pk_mul_f32 v[34:35], v[26:27], v[22:23] op_sel:[0,0] op_sel_hi:[0,1]
    v_pk_mul_f32 v[36:37], v[28:29], v[24:25] op_sel:[0,0] op_sel_hi:[0,1]
    v_pk_fma_f32 v[26:27], v[26:27], v[22:23], v[34:35] op_sel:[1,1,0] op_sel_hi:[1,0,1] neg_lo:[0,1,0]
    v_pk_fma_f32 v[28:29], v[28:29], v[24:25], v[36:37] op_sel:[1,1,0] op_sel_hi:[1,0,1] neg_lo:[0,1,0]
    v_cvt_pk_bf16_f32 v38, v26, v27
    v_cvt_pk_bf16_f32 v39, v28, v29
    v_pk_mul_f32 v[34:35], v[26:27], v[22:23] op_sel:[0,0] op_sel_hi:[0,1]
    v_pk_mul_f32 v[36:37], v[28:29], v[24:25] op_sel:[0,0] op_sel_hi:[0,1]
    v_pk_fma_f32 v[26:27], v[26:27], v[22:23], v[34:35] op_sel:[1,1,0] op_sel_hi:[1,0,1] neg_lo:[0,1,0]
    v_pk_fma_f32 v[28:29], v[28:29], v[24:25], v[36:37] op_sel:[1,1,0] op_sel_hi:[1,0,1] neg_lo:[0,1,0]
    v_cvt_pk_bf16_f32 v40, v26, v27
    v_cvt_pk_bf16_f32 v41, v28, v29
    v_pk_mul_f32 v[34:35], v[26:27], v[22:23] op_sel:[0,0] op_sel_hi:[0,1]
    v_pk_mul_f32 v[36:37], v[28:29], v[24:25] op_sel:[0,0] op_sel_hi:[0,1]
    v_pk_fma_f32 v[26:27], v[26:27], v[22:23], v[34:35] op_sel:[1,1,0] op_sel_hi:[1,0,1] neg_lo:[0,1,0]
    v_pk_fma_f32 v[28:29], v[28:29], v[24:25], v[36:37] op_sel:[1,1,0] op_sel_hi:[1,0,1] neg_lo:[0,1,0]
    v_cvt_pk_bf16_f32 v42, v26, v27
    v_cvt_pk_bf16_f32 v43, v28, v29
    v_pk_mul_f32 v[34:35], v[26:27], v[22:23] op_sel:[0,0] op_sel_hi:[0,1]
    v_pk_mul_f32 v[36:37], v[28:29], v[24:25] op_sel:[0,0] op_sel_hi:[0,1]
    v_pk_fma_f32 v[26:27], v[26:27], v[22:23], v[34:35] op_sel:[1,1,0] op_sel_hi:[1,0,1] neg_lo:[0,1,0]
    v_pk_fma_f32 v[28:29], v[28:29], v[24:25], v[36:37] op_sel:[1,1,0] op_sel_hi:[1,0,1] neg_lo:[0,1,0]
    v_cvt_pk_bf16_f32 v44, v26, v27
    v_cvt_pk_bf16_f32 v45, v28, v29
    ds_write_addtid_b32 v38 offset:8704
    ds_write_addtid_b32 v39 offset:8960
    ds_write_addtid_b32 v40 offset:9232
    ds_write_addtid_b32 v41 offset:9488
    ds_write_addtid_b32 v42 offset:9760
    ds_write_addtid_b32 v43 offset:10016
    ds_write_addtid_b32 v44 offset:10288
    ds_write_addtid_b32 v45 offset:10544
    v_pk_mul_f32 v[34:35], v[26:27], v[22:23] op_sel:[0,0] op_sel_hi:[0,1]
    v_pk_mul_f32 v[36:37], v[28:29], v[24:25] op_sel:[0,0] op_sel_hi:[0,1]
    v_pk_fma_f32 v[26:27], v[26:27], v[22:23], v[34:35] op_sel:[1,1,0] op_sel_hi:[1,0,1] neg_lo:[0,1,0]
    v_pk_fma_f32 v[28:29], v[28:29], v[24:25], v[36:37] op_sel:[1,1,0] op_sel_hi:[1,0,1] neg_lo:[0,1,0]
    v_cvt_pk_bf16_f32 v38, v26, v27
    v_cvt_pk_bf16_f32 v39, v28, v29
    v_pk_mul_f32 v[34:35], v[26:27], v[22:23] op_sel:[0,0] op_sel_hi:[0,1]
    v_pk_mul_f32 v[36:37], v[28:29], v[24:25] op_sel:[0,0] op_sel_hi:[0,1]
    v_pk_fma_f32 v[26:27], v[26:27], v[22:23], v[34:35] op_sel:[1,1,0] op_sel_hi:[1,0,1] neg_lo:[0,1,0]
    v_pk_fma_f32 v[28:29], v[28:29], v[24:25], v[36:37] op_sel:[1,1,0] op_sel_hi:[1,0,1] neg_lo:[0,1,0]
    v_cvt_pk_bf16_f32 v40, v26, v27
    v_cvt_pk_bf16_f32 v41, v28, v29
    v_pk_mul_f32 v[34:35], v[26:27], v[22:23] op_sel:[0,0] op_sel_hi:[0,1]
    v_pk_mul_f32 v[36:37], v[28:29], v[24:25] op_sel:[0,0] op_sel_hi:[0,1]
    v_pk_fma_f32 v[26:27], v[26:27], v[22:23], v[34:35] op_sel:[1,1,0] op_sel_hi:[1,0,1] neg_lo:[0,1,0]
    v_pk_fma_f32 v[28:29], v[28:29], v[24:25], v[36:37] op_sel:[1,1,0] op_sel_hi:[1,0,1] neg_lo:[0,1,0]
    v_cvt_pk_bf16_f32 v42, v26, v27
    v_cvt_pk_bf16_f32 v43, v28, v29
    v_pk_mul_f32 v[34:35], v[26:27], v[22:23] op_sel:[0,0] op_sel_hi:[0,1]
    v_pk_mul_f32 v[36:37], v[28:29], v[24:25] op_sel:[0,0] op_sel_hi:[0,1]
    v_pk_fma_f32 v[26:27], v[26:27], v[22:23], v[34:35] op_sel:[1,1,0] op_sel_hi:[1,0,1] neg_lo:[0,1,0]
    v_pk_fma_f32 v[28:29], v[28:29], v[24:25], v[36:37] op_sel:[1,1,0] op_sel_hi:[1,0,1] neg_lo:[0,1,0]
    v_cvt_pk_bf16_f32 v44, v26, v27
    v_cvt_pk_bf16_f32 v45, v28, v29
    ds_write_addtid_b32 v38 offset:10816
    ds_write_addtid_b32 v39 offset:11072
    ds_write_addtid_b32 v40 offset:11344
    ds_write_addtid_b32 v41 offset:11600
    ds_write_addtid_b32 v42 offset:11872
    ds_write_addtid_b32 v43 offset:12128
    ds_write_addtid_b32 v44 offset:12400
    ds_write_addtid_b32 v45 offset:12656
    v_pk_mul_f32 v[34:35], v[26:27], v[22:23] op_sel:[0,0] op_sel_hi:[0,1]
    v_pk_mul_f32 v[36:37], v[28:29], v[24:25] op_sel:[0,0] op_sel_hi:[0,1]
    v_pk_fma_f32 v[26:27], v[26:27], v[22:23], v[34:35] op_sel:[1,1,0] op_sel_hi:[1,0,1] neg_lo:[0,1,0]
    v_pk_fma_f32 v[28:29], v[28:29], v[24:25], v[36:37] op_sel:[1,1,0] op_sel_hi:[1,0,1] neg_lo:[0,1,0]
    v_cvt_pk_bf16_f32 v38, v26, v27
    v_cvt_pk_bf16_f32 v39, v28, v29
    ds_write_addtid_b32 v38 offset:12928
    ds_write_addtid_b32 v39 offset:13184
    s_waitcnt vmcnt(0)
    ds_read_b128 v[78:81], v3 offset:256
    ds_read_b128 v[82:85], v3 offset:320
    ds_read_b128 v[86:89], v3 offset:384
    ds_read_b128 v[90:93], v3 offset:448
    ds_read_b128 v[94:97], v3 offset:512
    ds_read_b128 v[98:101], v3 offset:576
    ds_read_b128 v[102:105], v3 offset:640
    ds_read_b128 v[106:109], v3 offset:704
    ds_read_b128 v[110:113], v3 offset:8704
    ds_read_b128 v[114:117], v3 offset:8768
    ds_read_b128 v[118:121], v3 offset:8832
    ds_read_b128 v[122:125], v3 offset:8896
    ds_read_b128 v[126:129], v3 offset:8960
    ds_read_b128 v[130:133], v3 offset:9024
    ds_read_b128 v[134:137], v3 offset:9088
    ds_read_b128 v[138:141], v3 offset:9152
    v_and_b32 v3, 15, v1
    v_lshrrev_b32 v4, 4, v1
    v_lshrrev_b32 v6, 5, v1
    v_bfe_u32 v7, v1, 2, 2
    v_and_b32 v8, 3, v1
    v_lshrrev_b32 v9, 2, v1
    v_bfe_u32 v10, v1, 4, 1
    s_mul_i32 s49, s32, 20384
    v_lshlrev_b32 v34, 4, v8
    v_lshl_add_u32 v32, v9, 8, v34
    v_add_u32 v15, s49, v32
    v_add_u32 v11, s49, v2
    v_mov_b32 v13, s49
    v_and_b32 v32, 31, v1
    v_lshl_add_u32 v14, v32, 3, s49
    v_lshl_add_u32 v16, v3, 4, s49
    v_lshl_add_u32 v32, v6, 5, v10
    v_lshl_add_u32 v17, v32, 3, v16
    v_bfe_u32 v32, v1, 1, 2
    v_mul_u32_u24 v32, 3296, v32
    v_min_u32 v32, 8800, v32
    v_and_b32 v33, 16, v2
    v_add3_u32 v18, v32, v33, s49
    s_add_u32 s36, s49, 256
    v_lshl_add_u32 v34, v7, 6, s36
    v_lshlrev_b32 v32, 1, v4
    v_sub_u32 v32, v8, v32
    v_lshl_add_u32 v33, v32, 2, 16
    v_lshl_add_u32 v19, v33, 1, v34
    v_ashrrev_i32 v33, 31, v33
    v_and_b32 v33, 192, v33
    v_sub_u32 v19, v19, v33
    v_lshl_add_u32 v33, v32, 2, 12
    v_lshl_add_u32 v20, v33, 1, v34
    v_ashrrev_i32 v33, 31, v33
    v_and_b32 v33, 192, v33
    v_sub_u32 v20, v20, v33
    s_add_u32 s36, s49, 18176
    v_lshl_add_u32 v34, v10, 4, s36
    v_mul_u32_u24 v32, 1296, v6
    v_lshl_add_u32 v32, v3, 2, v32
    v_sub_u32 v32, v34, v32
    v_add_u32 v21, 1356, v32
    v_and_b32 v33, 1, v1
    v_mul_u32_u24 v32, 386, v33
    v_lshl_add_u32 v32, v3, 1, v32
    v_sub_u32 v32, v34, v32
    v_mul_u32_u24 v34, 192, v6
    v_add_u32 v32, 672, v32
    v_add_u32 v22, v32, v34
    v_mul_u32_u24 v33, 190, v33
    v_and_b32 v32, 14, v1
    v_lshl_add_u32 v32, v4, 6, v32
    v_sub_u32 v32, v33, v32
    s_add_u32 s37, s36, 384
    v_add_u32 v32, s37, v32
    s_add_u32 s37, s36, 1552
    v_mov_b32 v34, s37
    v_cmp_gt_u32 vcc, 33, v1
    v_add_u32 v33, -48, v32
    s_add_u32 s37, s36, 1360
    v_cndmask_b32 v27, v34, v32, vcc
    v_cmp_gt_u32 vcc, 32, v1
    v_lshl_add_u32 v32, v4, 4, v3
    v_lshlrev_b32 v32, 3, v32
    v_cndmask_b32 v28, v34, v33, vcc
    v_lshl_add_u32 v33, v4, 5, v3
    v_lshlrev_b32 v33, 1, v33
    v_sub_u32 v33, 592, v33
    v_cndmask_b32 v32, v33, v32, vcc
    v_cmp_ne_u32 vcc, 0, v1
    v_mov_b32 v34, s37
    s_add_u32 s37, s36, 1024
    v_add_u32 v32, s37, v32
    v_cndmask_b32 v27, v34, v27, vcc
    v_mul_u32_u24 v33, 1300, v6
    v_sub_u32 v33, v32, v33
    v_add_u32 v24, 2, v33
    v_mul_u32_u24 v33, 36, v6
    v_sub_u32 v33, 4, v33
    v_add_u32 v25, v32, v33
    v_add_u32 v26, v24, v33
    v_cmp_ne_u32 vcc, 32, v1
    s_add_u32 s37, s37, 256
    v_mov_b32 v34, s37
    v_mov_b32 v29, 0x0c0c0c0c
    v_cndmask_b32 v23, v34, v32, vcc
    v_mov_b32 v30, v29
    v_mov_b32 v31, v29
    s_mov_b32 exec_lo, 0x10001
    s_mov_b32 exec_hi, 0x10001
    v_mov_b32 v29, 0x5040504
    v_mov_b32 v30, 0xc0c0504
    s_mov_b32 exec_lo, 0x100010
    s_mov_b32 exec_hi, 0x100010
    v_mov_b32 v29, 0x5040504
    v_mov_b32 v30, 0x5040504
    s_mov_b32 exec_lo, 0x1000100
    s_mov_b32 exec_hi, 0x1000100
    v_mov_b32 v29, 0x5040302
    v_mov_b32 v30, 0x5040504
    v_mov_b32 v31, 0xc0c0504
    s_mov_b32 exec_lo, 0x10001000
    s_mov_b32 exec_hi, 0x10001000
    v_mov_b32 v29, 0x3020100
    v_mov_b32 v30, 0x5040504
    v_mov_b32 v31, 0x5040504
    s_mov_b64 exec, -1
    v_mov_b32 v6, 0
    v_mov_b32 v7, 0
    v_mov_b32 v8, 0
    v_mov_b32 v9, 0
    ds_write_b128 v5, v[6:9] offset:15616
    ds_write_b128 v11, v[6:9] offset:18176
    ds_write_b128 v11, v[6:9] offset:19200
    s_waitcnt lgkmcnt(15)
    v_mfma_f32_16x16x32_bf16 v[32:35], v[46:49], a[0:3], 0
    v_mfma_f32_16x16x32_bf16 v[32:35], v[50:53], a[4:7], v[32:35]
    v_mfma_f32_16x16x32_bf16 v[32:35], v[54:57], a[8:11], v[32:35]
    v_mfma_f32_16x16x32_bf16 v[32:35], v[58:61], a[12:15], v[32:35]
    v_mfma_f32_16x16x32_bf16 v[32:35], v[62:65], a[16:19], v[32:35]
    v_mfma_f32_16x16x32_bf16 v[32:35], v[66:69], a[20:23], v[32:35]
    v_mfma_f32_16x16x32_bf16 v[32:35], v[70:73], a[24:27], v[32:35]
    v_mfma_f32_16x16x32_bf16 v[32:35], v[74:77], a[28:31], v[32:35]
    v_cmp_eq_u32 vcc, 0, v1
    v_mov_b32 v3, s48
    s_nop 0
    v_cndmask_b32 v3, 0, v3, vcc
    s_waitcnt lgkmcnt(11)
    v_mfma_f32_16x16x32_bf16 v[36:39], v[78:81], a[0:3], 0
    v_mfma_f32_16x16x32_bf16 v[36:39], v[82:85], a[4:7], v[36:39]
    v_mfma_f32_16x16x32_bf16 v[36:39], v[86:89], a[8:11], v[36:39]
    v_mfma_f32_16x16x32_bf16 v[36:39], v[90:93], a[12:15], v[36:39]
    v_mfma_f32_16x16x32_bf16 v[36:39], v[94:97], a[16:19], v[36:39]
    v_mfma_f32_16x16x32_bf16 v[36:39], v[98:101], a[20:23], v[36:39]
    v_mfma_f32_16x16x32_bf16 v[36:39], v[102:105], a[24:27], v[36:39]
    v_mfma_f32_16x16x32_bf16 v[36:39], v[106:109], a[28:31], v[36:39]
    v_add_f32 v32, v32, v3
    v_cvt_pk_bf16_f32 v142, v32, v33
    v_cvt_pk_bf16_f32 v143, v34, v35
    s_waitcnt lgkmcnt(3)
    v_mfma_f32_16x16x32_bf16 v[40:43], v[110:113], a[0:3], 0
    v_mfma_f32_16x16x32_bf16 v[40:43], v[114:117], a[4:7], v[40:43]
    v_mfma_f32_16x16x32_bf16 v[40:43], v[118:121], a[8:11], v[40:43]
    v_mfma_f32_16x16x32_bf16 v[40:43], v[122:125], a[12:15], v[40:43]
    v_mfma_f32_16x16x32_bf16 v[40:43], v[126:129], a[16:19], v[40:43]
    v_mfma_f32_16x16x32_bf16 v[40:43], v[130:133], a[20:23], v[40:43]
    v_mfma_f32_16x16x32_bf16 v[40:43], v[134:137], a[24:27], v[40:43]
    v_mfma_f32_16x16x32_bf16 v[40:43], v[138:141], a[28:31], v[40:43]
    ds_write_b64 v17, v[142:143] offset:256
    v_cvt_pk_bf16_f32 v144, v36, v37
    v_cvt_pk_bf16_f32 v145, v38, v39
    ds_write_b16 v23, v144
    ds_write_b16_d16_hi v24, v144
    ds_write_b16 v25, v145
    ds_write_b16_d16_hi v26, v145
    ds_read_b64 v[44:45], v14 offset:19200
    ds_read_b32 v46, v14 offset:19208
    ds_read_b32 v48, v13 offset:19452
    ds_read_b32 v49, v13 offset:19456
    v_cvt_pk_bf16_f32 v146, v40, v41
    v_cvt_pk_bf16_f32 v147, v42, v43
    ds_write_b16 v27, v146 offset:0
    ds_write_b16_d16_hi v28, v146 offset:32
    ds_write_b16 v28, v147 offset:16
    ds_write_b16_d16_hi v28, v147 offset:0
    ds_write_b16 v27, v146 offset:386
    ds_write_b16_d16_hi v28, v146 offset:418
    ds_write_b16 v28, v147 offset:402
    ds_write_b16_d16_hi v28, v147 offset:386
    s_mov_b32 s9, 0x01000100
    ds_read_u16 v24, v13 offset:19536
    s_waitcnt lgkmcnt(11)
    v_perm_b32 v32, v44, v44, s9
    v_alignbit_b32 v33, v45, v44, 16
    v_perm_b32 v34, v45, v45, s9
    v_alignbit_b32 v35, v46, v45, 16
    ds_write_b128 v5, v[32:35] offset:768
    ds_read_b64 v[50:51], v11 offset:248
    ds_read_b128 v[52:55], v11 offset:256
    s_waitcnt lgkmcnt(12)
    v_perm_b32 v36, v49, v48, v29
    v_perm_b32 v37, v49, v48, v30
    v_perm_b32 v38, v49, v48, v31
    v_mov_b32 v39, 0
    v_mov_b32 v6, 0
    v_mov_b32 v7, 0
    v_mov_b32 v8, 0
    v_mov_b32 v9, 0
    ds_write_b128 v16, v[36:39] offset:4352
    ds_write_b128 v18, v[6:9] offset:4608
    ds_read2_b32 a[0:1], v21 offset0:40 offset1:41
    ds_read2_b32 a[2:3], v21 offset0:42 offset1:43
    ds_read2_b32 a[4:5], v21 offset0:32 offset1:33
    ds_read2_b32 a[6:7], v21 offset0:34 offset1:35
    ds_read2_b32 a[8:9], v21 offset0:24 offset1:25
    ds_read2_b32 a[10:11], v21 offset0:26 offset1:27
    ds_read2_b32 a[12:13], v21 offset0:16 offset1:17
    ds_read2_b32 a[14:15], v21 offset0:18 offset1:19
    ds_read2_b32 a[16:17], v21 offset0:8 offset1:9
    ds_read2_b32 a[18:19], v21 offset0:10 offset1:11
    ds_read2_b32 a[20:21], v21 offset0:0 offset1:1
    ds_read2_b32 a[22:23], v21 offset0:2 offset1:3
    s_waitcnt lgkmcnt(14)
    v_lshlrev_b32 v24, 16, v24
    ds_write_b128 v15, v[52:55] offset:256
    v_alignbit_b32 v32, v52, v51, 16
    v_alignbit_b32 v33, v53, v52, 16
    v_alignbit_b32 v34, v54, v53, 16
    v_alignbit_b32 v35, v55, v54, 16
    ds_write_b128 v15, v[32:35] offset:320
    v_mov_b32 v36, v51
    v_mov_b32 v37, v52
    v_mov_b32 v38, v53
    v_mov_b32 v39, v54
    ds_write_b128 v15, v[36:39] offset:384
    v_alignbit_b32 v40, v51, v50, 16
    v_alignbit_b32 v41, v52, v51, 16
    v_alignbit_b32 v42, v53, v52, 16
    v_alignbit_b32 v43, v54, v53, 16
    ds_write_b128 v15, v[40:43] offset:448
    ds_read2_b32 a[24:25], v22 offset0:24 offset1:25
    ds_read2_b32 a[26:27], v22 offset0:26 offset1:27
    ds_read2_b32 a[28:29], v22 offset0:16 offset1:17
    ds_read2_b32 a[30:31], v22 offset0:18 offset1:19
    ds_read2_b32 a[32:33], v22 offset0:8 offset1:9
    ds_read2_b32 a[34:35], v22 offset0:10 offset1:11
    ds_read2_b32 a[36:37], v22 offset0:0 offset1:1
    ds_read2_b32 a[38:39], v22 offset0:2 offset1:3
    ds_read_b64_tr_b16 a[40:41], v19 offset:0
    ds_read_b64_tr_b16 a[42:43], v20 offset:0
    ds_read_b64_tr_b16 a[44:45], v19 offset:256
    ds_read_b64_tr_b16 a[46:47], v20 offset:256
    ds_read_b64_tr_b16 v[56:57], v19 offset:512
    ds_read_b64_tr_b16 v[58:59], v20 offset:512
    ds_read_b64_tr_b16 v[60:61], v19 offset:768
    ds_read_b64_tr_b16 v[62:63], v20 offset:768
    ds_read_b64_tr_b16 v[64:65], v19 offset:1024
    ds_read_b64_tr_b16 v[66:67], v20 offset:1024
    ds_read_b64_tr_b16 v[68:69], v19 offset:1280
    ds_read_b64_tr_b16 v[70:71], v20 offset:1280
    ds_read_b64_tr_b16 v[72:73], v19 offset:1536
    ds_read_b64_tr_b16 v[74:75], v20 offset:1536
    ds_read_b64_tr_b16 v[76:77], v19 offset:1792
    ds_read_b64_tr_b16 v[78:79], v20 offset:1792
    ds_read_b64_tr_b16 v[80:81], v19 offset:2048
    ds_read_b64_tr_b16 v[82:83], v20 offset:2048
    ds_read_b64_tr_b16 v[84:85], v19 offset:2304
    ds_read_b64_tr_b16 v[86:87], v20 offset:2304
    ds_read_b64_tr_b16 v[88:89], v19 offset:2560
    ds_read_b64_tr_b16 v[90:91], v20 offset:2560
    ds_read_b64_tr_b16 v[92:93], v19 offset:2816
    ds_read_b64_tr_b16 v[94:95], v20 offset:2816
    ds_read_b64_tr_b16 v[96:97], v19 offset:3072
    ds_read_b64_tr_b16 v[98:99], v20 offset:3072
    ds_read_b64_tr_b16 v[100:101], v19 offset:3328
    ds_read_b64_tr_b16 v[102:103], v20 offset:3328
    ds_read_b64_tr_b16 v[104:105], v19 offset:3584
    ds_read_b64_tr_b16 v[106:107], v20 offset:3584
    ds_read_b64_tr_b16 v[108:109], v19 offset:3840
    ds_read_b64_tr_b16 v[110:111], v20 offset:3840
    ds_read_b64_tr_b16 v[112:113], v19 offset:4096
    ds_read_b64_tr_b16 v[114:115], v20 offset:4096
    v_and_b32 v3, 15, v1
    v_lshrrev_b32 v4, 4, v1
    v_lshrrev_b32 v5, 5, v1
    v_bfe_u32 v6, v1, 2, 2
    v_and_b32 v7, 3, v1
    v_lshrrev_b32 v8, 2, v1
    v_bfe_u32 v9, v1, 4, 1
    s_mul_i32 s49, s32, 20384
    v_lshl_add_u32 v21, v3, 1, v4
    v_lshl_add_u32 v10, v21, 4, s49
    v_lshl_add_u32 v23, v3, 5, s49
    v_add_u32 v21, v4, v6
    v_lshl_add_u32 v11, v21, 3, v23
    v_and_b32 v21, 3, v21
    v_lshl_add_u32 v13, v21, 3, v23
    v_add_u32 v21, v4, v7
    v_and_b32 v21, 3, v21
    v_lshl_add_u32 v21, v4, 4, v21
    v_mul_u32_u24 v22, 20384, v6
    v_lshl_add_u32 v21, v21, 3, v22
    s_lshl_b32 s36, s32, 9
    v_add_u32 v14, s36, v21
    v_lshlrev_b32 v21, 3, v3
    v_lshl_add_u32 v15, v4, 9, v21
    v_mul_u32_u24 v21, 20384, v7
    v_lshl_add_u32 v21, v8, 4, v21
    s_lshl_b32 s36, s32, 10
    v_add_u32 v16, s36, v21
    v_lshl_add_u32 v23, v9, 3, v6
    v_lshl_add_u32 v21, v5, 0, v7
    v_lshl_add_u32 v21, v23, 1, v21
    s_add_u32 s36, s49, 4640
    v_mul_u32_u24 v18, 3296, v5
    v_add_u32 v18, s36, v18
    v_add_u32 v21, -3, v21
    v_ashrrev_i32 v22, 4, v21
    v_add_lshl_u32 v22, v21, v22, 3
    v_add_u32 v17, v18, v22
    v_add_u32 v21, 8, v21
    v_ashrrev_i32 v22, 4, v21
    v_add_lshl_u32 v22, v21, v22, 3
    v_add_u32 v18, v18, v22
    v_lshl_add_u32 v21, v5, 1, v7
    v_lshl_add_u32 v21, v23, 2, v21
    s_add_u32 s36, s49, 11232
    v_mul_u32_u24 v20, 2208, v5
    v_add_u32 v20, s36, v20
    v_add_u32 v21, -3, v21
    v_ashrrev_i32 v22, 4, v21
    v_add_lshl_u32 v22, v21, v22, 3
    v_add_u32 v19, v20, v22
    v_add_u32 v21, 16, v21
    v_ashrrev_i32 v22, 4, v21
    v_add_lshl_u32 v22, v21, v22, 3
    v_add_u32 v20, v20, v22
    v_lshlrev_b32 v21, 3, v4
    v_sub_u32 v21, v21, v3
    v_cvt_f32_i32 v21, v21
    v_add_f32 v44, 0xc1400000, v21
    v_add_f32 v45, 0xc1300000, v21
    v_add_f32 v46, 0xc1200000, v21
    v_add_f32 v47, 0xc1100000, v21
    v_add_f32 v48, 0xc1000000, v21
    v_add_f32 v49, 0xc0e00000, v21
    v_add_f32 v50, 0xc0c00000, v21
    v_add_f32 v51, 0xc0a00000, v21
    s_mov_b32 s37, 0x40400000
    v_sub_f32 v52, s37, abs(v44) clamp
    v_sub_f32 v53, s37, abs(v45) clamp
    v_cvt_pk_bf16_f32 v28, v52, v53
    v_sub_f32 v52, s37, abs(v46) clamp
    v_sub_f32 v53, s37, abs(v47) clamp
    v_cvt_pk_bf16_f32 v29, v52, v53
    v_sub_f32 v52, s37, abs(v48) clamp
    v_sub_f32 v53, s37, abs(v49) clamp
    v_cvt_pk_bf16_f32 v30, v52, v53
    v_sub_f32 v52, s37, abs(v50) clamp
    v_sub_f32 v53, s37, abs(v51) clamp
    v_cvt_pk_bf16_f32 v31, v52, v53
    v_sub_f32 v52, 2.0, abs(v44) clamp
    v_sub_f32 v53, 2.0, abs(v45) clamp
    v_cvt_pk_bf16_f32 v32, v52, v53
    v_sub_f32 v52, 2.0, abs(v46) clamp
    v_sub_f32 v53, 2.0, abs(v47) clamp
    v_cvt_pk_bf16_f32 v33, v52, v53
    v_sub_f32 v52, 2.0, abs(v48) clamp
    v_sub_f32 v53, 2.0, abs(v49) clamp
    v_cvt_pk_bf16_f32 v34, v52, v53
    v_sub_f32 v52, 2.0, abs(v50) clamp
    v_sub_f32 v53, 2.0, abs(v51) clamp
    v_cvt_pk_bf16_f32 v35, v52, v53
    s_mov_b32 s37, 0x40a00000
    v_sub_f32 v52, s37, abs(v44) clamp
    v_sub_f32 v53, s37, abs(v45) clamp
    v_cvt_pk_bf16_f32 v36, v52, v53
    v_sub_f32 v52, s37, abs(v46) clamp
    v_sub_f32 v53, s37, abs(v47) clamp
    v_cvt_pk_bf16_f32 v37, v52, v53
    v_sub_f32 v52, s37, abs(v48) clamp
    v_sub_f32 v53, s37, abs(v49) clamp
    v_cvt_pk_bf16_f32 v38, v52, v53
    v_sub_f32 v52, s37, abs(v50) clamp
    v_sub_f32 v53, s37, abs(v51) clamp
    v_cvt_pk_bf16_f32 v39, v52, v53
    v_sub_f32 v52, 4.0, abs(v44) clamp
    v_sub_f32 v53, 4.0, abs(v45) clamp
    v_cvt_pk_bf16_f32 v40, v52, v53
    v_sub_f32 v52, 4.0, abs(v46) clamp
    v_sub_f32 v53, 4.0, abs(v47) clamp
    v_cvt_pk_bf16_f32 v41, v52, v53
    v_sub_f32 v52, 4.0, abs(v48) clamp
    v_sub_f32 v53, 4.0, abs(v49) clamp
    v_cvt_pk_bf16_f32 v42, v52, v53
    v_sub_f32 v52, 4.0, abs(v50) clamp
    v_sub_f32 v53, 4.0, abs(v51) clamp
    v_cvt_pk_bf16_f32 v43, v52, v53
    v_add_f32 v44, -0.5, v44
    v_sub_f32 v44, 1.0, abs(v44) clamp
    v_add_f32 v45, -0.5, v45
    v_sub_f32 v45, 1.0, abs(v45) clamp
    v_add_f32 v46, -0.5, v46
    v_sub_f32 v46, 1.0, abs(v46) clamp
    v_add_f32 v47, -0.5, v47
    v_sub_f32 v47, 1.0, abs(v47) clamp
    v_add_f32 v48, -0.5, v48
    v_sub_f32 v48, 1.0, abs(v48) clamp
    v_add_f32 v49, -0.5, v49
    v_sub_f32 v49, 1.0, abs(v49) clamp
    v_add_f32 v50, -0.5, v50
    v_sub_f32 v50, 1.0, abs(v50) clamp
    v_add_f32 v51, -0.5, v51
    v_sub_f32 v51, 1.0, abs(v51) clamp
    v_add_f32 v21, v24, v24
    v_mul_f32 v44, v21, v44
    v_mul_f32 v45, v21, v45
    v_mul_f32 v46, v21, v46
    v_mul_f32 v47, v21, v47
    v_mul_f32 v48, v21, v48
    v_mul_f32 v49, v21, v49
    v_mul_f32 v50, v21, v50
    v_mul_f32 v51, v21, v51
    v_cvt_pk_bf16_f32 v24, v44, v45
    v_cvt_pk_bf16_f32 v25, v46, v47
    v_cvt_pk_bf16_f32 v26, v48, v49
    v_cvt_pk_bf16_f32 v27, v50, v51
    s_sleep 8
    buffer_load_dwordx4 v[116:119], v2, s[52:55], s50 offen offset:0 sc1
    buffer_load_dwordx4 v[120:123], v2, s[52:55], s50 offen offset:1024 sc1
    buffer_load_dwordx4 v[124:127], v2, s[52:55], s50 offen offset:2048 sc1
    buffer_load_dwordx4 v[128:131], v2, s[52:55], s50 offen offset:3072 sc1
    s_waitcnt lgkmcnt(0)
    s_barrier
    s_waitcnt vmcnt(0)
    v_bitop3_b32 v4, v116, v120, s4 bitop3:0x7e
    v_bitop3_b32 v5, v124, v128, s4 bitop3:0x7e
    v_or3_b32 v3, v4, v5, 0
    v_bitop3_b32 v4, v117, v121, s5 bitop3:0x7e
    v_bitop3_b32 v5, v125, v129, s5 bitop3:0x7e
    v_or3_b32 v3, v4, v5, v3
    v_bitop3_b32 v4, v118, v122, s6 bitop3:0x7e
    v_bitop3_b32 v5, v126, v130, s6 bitop3:0x7e
    v_or3_b32 v3, v4, v5, v3
    v_bitop3_b32 v4, v119, v123, s7 bitop3:0x7e
    v_bitop3_b32 v5, v127, v131, s7 bitop3:0x7e
    v_or3_b32 v3, v4, v5, v3
    v_and_b32 v3, 0x10001, v3
    v_cmp_ne_u32 vcc, 0, v3
    s_cbranch_vccnz Lre47
Lok46:
    ds_write_b128 v16, v[116:119] offset:16128
    ds_write_b128 v16, v[120:123] offset:16384
    ds_write_b128 v16, v[124:127] offset:16640
    ds_write_b128 v16, v[128:131] offset:16896
    s_xor_b32 s5, s5, 1
    v_and_b32 v3, 1, v1
    v_sub_u32 v3, 0, v3
    v_mov_b32 v8, s4
    v_mov_b32 v4, s6
    v_bfi_b32 v8, v3, v4, v8
    v_mov_b32 v9, s5
    v_mov_b32 v4, s7
    v_bfi_b32 v9, v3, v4, v9
    s_cmp_lg_u32 s32, 0
    s_cbranch_scc1 Lgk54
    v_mov_b32 v3, 0
    s_lshl_b32 s36, s33, 7
    s_add_u32 s36, s36, 21168128
    s_movk_i32 s37, 10
Lgl53:
    buffer_load_dword v16, v3, s[52:55], s36 offen sc1
    s_sub_u32 s37, s37, 1
    s_waitcnt vmcnt(0)
    v_cmp_ne_u32 vcc, s8, v16
    s_cbranch_vccz Lgk54
    s_sleep 2
    s_cmp_lg_u32 s37, 0
    s_cbranch_scc1 Lgl53
Lgk54:
    s_waitcnt lgkmcnt(0)
    s_barrier
    s_setprio 3
    ds_read_b128 v[148:151], v10 offset:15648
    ds_read_b128 v[152:155], v10 offset:15712
    ds_read_b128 v[156:159], v10 offset:15776
    ds_read_b128 v[160:163], v10 offset:15840
    ds_read_b128 v[164:167], v10 offset:15904
    s_waitcnt lgkmcnt(4)
    v_mfma_f32_16x16x32_bf16 v[116:119], v[76:79], v[148:151], 0
    ds_read_b128 v[168:171], v10 offset:15968
    v_mfma_f32_16x16x32_bf16 v[120:123], v[108:111], v[148:151], 0
    ds_read_b128 v[172:175], v10 offset:16032
    s_waitcnt lgkmcnt(5)
    v_mfma_f32_16x16x32_bf16 v[116:119], v[72:75], v[152:155], v[116:119]
    ds_read_b128 v[176:179], v10 offset:16096
    v_mfma_f32_16x16x32_bf16 v[120:123], v[104:107], v[152:155], v[120:123]
    ds_read_b128 v[148:151], v10 offset:16160
    s_waitcnt lgkmcnt(6)
    v_mfma_f32_16x16x32_bf16 v[116:119], v[68:71], v[156:159], v[116:119]
    ds_read_b128 v[152:155], v10 offset:16224
    v_mfma_f32_16x16x32_bf16 v[120:123], v[100:103], v[156:159], v[120:123]
    ds_read_b128 v[156:159], v10 offset:16288
    s_waitcnt lgkmcnt(7)
    v_mfma_f32_16x16x32_bf16 v[116:119], v[64:67], v[160:163], v[116:119]
    v_mfma_f32_16x16x32_bf16 v[120:123], v[96:99], v[160:163], v[120:123]
    ds_read_b128 v[160:163], v10 offset:16352
    s_waitcnt lgkmcnt(7)
    v_mfma_f32_16x16x32_bf16 v[116:119], v[60:63], v[164:167], v[116:119]
    v_mfma_f32_16x16x32_bf16 v[120:123], v[92:95], v[164:167], v[120:123]
    ds_read_b128 v[164:167], v10 offset:16416
    s_waitcnt lgkmcnt(7)
    v_mfma_f32_16x16x32_bf16 v[116:119], v[56:59], v[168:171], v[116:119]
    v_mfma_f32_16x16x32_bf16 v[120:123], v[88:91], v[168:171], v[120:123]
    ds_read_b128 v[168:171], v10 offset:16480
    s_waitcnt lgkmcnt(7)
    v_mfma_f32_16x16x32_bf16 v[116:119], a[44:47], v[172:175], v[116:119]
    v_mfma_f32_16x16x32_bf16 v[120:123], v[84:87], v[172:175], v[120:123]
    ds_read_b128 v[172:175], v10 offset:16544
    s_waitcnt lgkmcnt(7)
    v_mfma_f32_16x16x32_bf16 v[132:135], v[24:27], v[176:179], 0
    v_mfma_f32_16x16x32_bf16 v[44:47], v[28:31], v[176:179], 0
    v_mfma_f32_16x16x32_bf16 v[116:119], a[40:43], v[176:179], v[116:119]
    v_mfma_f32_16x16x32_bf16 v[120:123], v[80:83], v[176:179], v[120:123]
    v_mfma_f32_16x16x32_bf16 v[124:127], v[112:115], v[176:179], 0
    v_mfma_f32_16x16x32_bf16 v[48:51], v[32:35], v[176:179], 0
    s_nop 3
    v_cvt_pk_bf16_f32 v4, v44, v45
    v_cvt_pk_bf16_f32 v5, v46, v47
    s_waitcnt lgkmcnt(6)
    v_mfma_f32_16x16x32_bf16 v[120:123], v[76:79], v[148:151], v[120:123]
    ds_write_b64 v11, v[4:5] offset:4640
    v_mfma_f32_16x16x32_bf16 v[124:127], v[108:111], v[148:151], v[124:127]
    ds_read_b128 v[148:151], v10 offset:16608
    v_mfma_f32_16x16x32_bf16 v[52:55], v[36:39], v[176:179], 0
    s_waitcnt lgkmcnt(7)
    v_mfma_f32_16x16x32_bf16 v[120:123], v[72:75], v[152:155], v[120:123]
    v_cvt_pk_bf16_f32 v6, v48, v49
    v_cvt_pk_bf16_f32 v7, v50, v51
    v_mfma_f32_16x16x32_bf16 v[124:127], v[104:107], v[152:155], v[124:127]
    ds_write_b64 v11, v[6:7] offset:7936
    v_mfma_f32_16x16x32_bf16 v[44:47], v[40:43], v[176:179], 0
    ds_read_b128 v[152:155], v10 offset:16672
    s_waitcnt lgkmcnt(8)
    v_mfma_f32_16x16x32_bf16 v[120:123], v[68:71], v[156:159], v[120:123]
    v_cvt_pk_bf16_f32 v4, v52, v53
    v_cvt_pk_bf16_f32 v5, v54, v55
    v_mfma_f32_16x16x32_bf16 v[124:127], v[100:103], v[156:159], v[124:127]
    ds_write_b64 v11, v[4:5] offset:11232
    s_waitcnt lgkmcnt(8)
    v_mfma_f32_16x16x32_bf16 v[120:123], v[64:67], v[160:163], v[120:123]
    ds_read_b128 v[176:179], v10 offset:16736
    v_mfma_f32_16x16x32_bf16 v[124:127], v[96:99], v[160:163], v[124:127]
    v_cvt_pk_bf16_f32 v6, v44, v45
    v_cvt_pk_bf16_f32 v7, v46, v47
    s_waitcnt lgkmcnt(8)
    v_mfma_f32_16x16x32_bf16 v[120:123], v[60:63], v[164:167], v[120:123]
    ds_write_b64 v11, v[6:7] offset:13440
    v_mfma_f32_16x16x32_bf16 v[124:127], v[92:95], v[164:167], v[124:127]
    ds_read_b128 v[156:159], v10 offset:16800
    s_waitcnt lgkmcnt(9)
    v_mfma_f32_16x16x32_bf16 v[120:123], v[56:59], v[168:171], v[120:123]
    ds_read_b128 v[160:163], v10 offset:16864
    v_mfma_f32_16x16x32_bf16 v[124:127], v[88:91], v[168:171], v[124:127]
    ds_read_b128 v[164:167], v10 offset:16928
    s_waitcnt lgkmcnt(10)
    v_mfma_f32_16x16x32_bf16 v[120:123], a[44:47], v[172:175], v[120:123]
    ds_read_b128 v[168:171], v10 offset:16992
    v_mfma_f32_16x16x32_bf16 v[124:127], v[84:87], v[172:175], v[124:127]
    ds_read_b128 v[172:175], v10 offset:17056
    s_waitcnt lgkmcnt(10)
    v_mfma_f32_16x16x32_bf16 v[136:139], v[24:27], v[148:151], 0
    v_mfma_f32_16x16x32_bf16 v[48:51], v[28:31], v[148:151], 0
    v_mfma_f32_16x16x32_bf16 v[120:123], a[40:43], v[148:151], v[120:123]
    v_mfma_f32_16x16x32_bf16 v[124:127], v[80:83], v[148:151], v[124:127]
    v_mfma_f32_16x16x32_bf16 v[128:131], v[112:115], v[148:151], 0
    v_mfma_f32_16x16x32_bf16 v[52:55], v[32:35], v[148:151], 0
    s_nop 3
    v_cvt_pk_bf16_f32 v4, v48, v49
    v_cvt_pk_bf16_f32 v5, v50, v51
    s_waitcnt lgkmcnt(8)
    v_mfma_f32_16x16x32_bf16 v[124:127], v[76:79], v[152:155], v[124:127]
    ds_write_b64 v11, v[4:5] offset:5184
    v_mfma_f32_16x16x32_bf16 v[128:131], v[108:111], v[152:155], v[128:131]
    ds_read_b128 v[152:155], v10 offset:17120
    v_mfma_f32_16x16x32_bf16 v[44:47], v[36:39], v[148:151], 0
    s_waitcnt lgkmcnt(8)
    v_mfma_f32_16x16x32_bf16 v[124:127], v[72:75], v[176:179], v[124:127]
    v_cvt_pk_bf16_f32 v6, v52, v53
    v_cvt_pk_bf16_f32 v7, v54, v55
    v_mfma_f32_16x16x32_bf16 v[128:131], v[104:107], v[176:179], v[128:131]
    ds_write_b64 v11, v[6:7] offset:8480
    v_mfma_f32_16x16x32_bf16 v[48:51], v[40:43], v[148:151], 0
    ds_read_b128 v[176:179], v10 offset:17184
    s_waitcnt lgkmcnt(8)
    v_mfma_f32_16x16x32_bf16 v[124:127], v[68:71], v[156:159], v[124:127]
    v_cvt_pk_bf16_f32 v4, v44, v45
    v_cvt_pk_bf16_f32 v5, v46, v47
    v_mfma_f32_16x16x32_bf16 v[128:131], v[100:103], v[156:159], v[128:131]
    ds_write_b64 v11, v[4:5] offset:11776
    s_waitcnt lgkmcnt(8)
    v_mfma_f32_16x16x32_bf16 v[124:127], v[64:67], v[160:163], v[124:127]
    ds_read_b128 v[148:151], v10 offset:17248
    v_mfma_f32_16x16x32_bf16 v[128:131], v[96:99], v[160:163], v[128:131]
    v_cvt_pk_bf16_f32 v6, v48, v49
    v_cvt_pk_bf16_f32 v7, v50, v51
    s_waitcnt lgkmcnt(8)
    v_mfma_f32_16x16x32_bf16 v[124:127], v[60:63], v[164:167], v[124:127]
    ds_write_b64 v11, v[6:7] offset:13984
    v_mfma_f32_16x16x32_bf16 v[128:131], v[92:95], v[164:167], v[128:131]
    ds_read_b64_tr_b16 v[180:181], v17 offset:0
    ds_read_b64_tr_b16 v[182:183], v18 offset:0
    s_waitcnt lgkmcnt(10)
    v_mfma_f32_16x16x32_bf16 v[124:127], v[56:59], v[168:171], v[124:127]
    ds_read_b128 v[156:159], v10 offset:17312
    v_mfma_f32_16x16x32_bf16 v[128:131], v[88:91], v[168:171], v[128:131]
    ds_read_b128 v[160:163], v10 offset:17376
    s_waitcnt lgkmcnt(11)
    v_mfma_f32_16x16x32_bf16 v[124:127], a[44:47], v[172:175], v[124:127]
    ds_read_b64_tr_b16 v[184:185], v17 offset:272
    ds_read_b64_tr_b16 v[186:187], v18 offset:272
    v_mfma_f32_16x16x32_bf16 v[128:131], v[84:87], v[172:175], v[128:131]
    ds_read_b128 v[164:167], v10 offset:17440
    s_waitcnt lgkmcnt(12)
    v_mfma_f32_16x16x32_bf16 v[140:143], v[24:27], v[152:155], 0
    ds_read_b128 v[168:171], v10 offset:17504
    v_mfma_f32_16x16x32_bf16 v[52:55], v[28:31], v[152:155], 0
    ds_read_b64_tr_b16 v[188:189], v17 offset:544
    ds_read_b64_tr_b16 v[190:191], v18 offset:544
    v_mfma_f32_16x16x32_bf16 v[124:127], a[40:43], v[152:155], v[124:127]
    ds_read_b128 v[172:175], v10 offset:17568
    v_mfma_f32_16x16x32_bf16 v[128:131], v[80:83], v[152:155], v[128:131]
    v_mfma_f32_16x16x32_bf16 v[132:135], v[112:115], v[152:155], v[132:135]
    v_mfma_f32_16x16x32_bf16 v[44:47], v[32:35], v[152:155], 0
    s_nop 0
    v_cvt_pk_bf16_f32 v4, v52, v53
    v_cvt_pk_bf16_f32 v5, v54, v55
    s_waitcnt lgkmcnt(14)
    v_mfma_f32_16x16x32_bf16 v[128:131], v[76:79], v[176:179], v[128:131]
    ds_write_b64 v11, v[4:5] offset:5728
    v_mfma_f32_16x16x32_bf16 v[132:135], v[108:111], v[176:179], v[132:135]
    v_mfma_f32_16x16x32_bf16 v[48:51], v[36:39], v[152:155], 0
    s_waitcnt lgkmcnt(13)
    v_mfma_f32_16x16x32_bf16 v[128:131], v[72:75], v[148:151], v[128:131]
    v_cvt_pk_bf16_f32 v6, v44, v45
    v_cvt_pk_bf16_f32 v7, v46, v47
    v_mfma_f32_16x16x32_bf16 v[132:135], v[104:107], v[148:151], v[132:135]
    ds_write_b64 v11, v[6:7] offset:9024
    s_waitcnt lgkmcnt(11)
    v_mfma_f32_16x16x32_bf16 v[124:127], v[180:183], a[4:7], v[124:127]
    v_mfma_f32_16x16x32_bf16 v[128:131], v[180:183], a[12:15], v[128:131]
    v_cvt_pk_bf16_f32 v4, v48, v49
    v_cvt_pk_bf16_f32 v5, v50, v51
    v_mfma_f32_16x16x32_bf16 v[132:135], v[180:183], a[20:23], v[132:135]
    ds_write_b64 v11, v[4:5] offset:12320
    v_mfma_f32_16x16x32_bf16 v[52:55], v[40:43], v[152:155], 0
    ds_read_b64_tr_b16 v[180:181], v17 offset:816
    ds_read_b64_tr_b16 v[182:183], v18 offset:816
    s_waitcnt lgkmcnt(13)
    v_mfma_f32_16x16x32_bf16 v[128:131], v[68:71], v[156:159], v[128:131]
    ds_read_b128 v[176:179], v10 offset:17632
    v_mfma_f32_16x16x32_bf16 v[132:135], v[100:103], v[156:159], v[132:135]
    ds_read_b128 v[148:151], v10 offset:17696
    s_waitcnt lgkmcnt(14)
    v_mfma_f32_16x16x32_bf16 v[128:131], v[64:67], v[160:163], v[128:131]
    ds_read_b128 v[152:155], v10 offset:17760
    v_mfma_f32_16x16x32_bf16 v[132:135], v[96:99], v[160:163], v[132:135]
    v_cvt_pk_bf16_f32 v6, v52, v53
    v_cvt_pk_bf16_f32 v7, v54, v55
    s_waitcnt lgkmcnt(13)
    v_mfma_f32_16x16x32_bf16 v[124:127], v[184:187], a[0:3], v[124:127]
    ds_write_b64 v11, v[6:7] offset:14528
    v_mfma_f32_16x16x32_bf16 v[128:131], v[184:187], a[8:11], v[128:131]
    v_mfma_f32_16x16x32_bf16 v[132:135], v[184:187], a[16:19], v[132:135]
    ds_read_b64_tr_b16 v[184:185], v17 offset:1088
    ds_read_b64_tr_b16 v[186:187], v18 offset:1088
    s_waitcnt lgkmcnt(15)
    v_mfma_f32_16x16x32_bf16 v[128:131], v[60:63], v[164:167], v[128:131]
    ds_read_b128 v[156:159], v10 offset:17824
    v_mfma_f32_16x16x32_bf16 v[132:135], v[92:95], v[164:167], v[132:135]
    ds_read_b128 v[160:163], v10 offset:17888
    s_waitcnt lgkmcnt(15)
    v_mfma_f32_16x16x32_bf16 v[128:131], v[56:59], v[168:171], v[128:131]
    v_mfma_f32_16x16x32_bf16 v[132:135], v[88:91], v[168:171], v[132:135]
    s_waitcnt lgkmcnt(14)
    v_mfma_f32_16x16x32_bf16 v[128:131], v[188:191], a[4:7], v[128:131]
    v_mfma_f32_16x16x32_bf16 v[132:135], v[188:191], a[12:15], v[132:135]
    v_mfma_f32_16x16x32_bf16 v[136:139], v[188:191], a[20:23], v[136:139]
    ds_read_b64_tr_b16 v[188:189], v19 offset:0
    ds_read_b64_tr_b16 v[190:191], v20 offset:0
    s_waitcnt lgkmcnt(15)
    v_mfma_f32_16x16x32_bf16 v[128:131], a[44:47], v[172:175], v[128:131]
    ds_read_b128 v[164:167], v10 offset:17952
    v_mfma_f32_16x16x32_bf16 v[132:135], v[84:87], v[172:175], v[132:135]
    ds_read_b128 v[168:171], v10 offset:18016
    s_waitcnt lgkmcnt(12)
    v_mfma_f32_16x16x32_bf16 v[128:131], v[180:183], a[0:3], v[128:131]
    v_mfma_f32_16x16x32_bf16 v[132:135], v[180:183], a[8:11], v[132:135]
    v_mfma_f32_16x16x32_bf16 v[136:139], v[180:183], a[16:19], v[136:139]
    ds_read_b64_tr_b16 v[180:181], v17 offset:1360
    ds_read_b64_tr_b16 v[182:183], v18 offset:1360
    s_waitcnt lgkmcnt(13)
    v_mfma_f32_16x16x32_bf16 v[144:147], v[24:27], v[176:179], 0
    ds_read_b128 v[172:175], v10 offset:18080
    v_mfma_f32_16x16x32_bf16 v[44:47], v[28:31], v[176:179], 0
    v_mfma_f32_16x16x32_bf16 v[128:131], a[40:43], v[176:179], v[128:131]
    v_mfma_f32_16x16x32_bf16 v[132:135], v[80:83], v[176:179], v[132:135]
    v_mfma_f32_16x16x32_bf16 v[136:139], v[112:115], v[176:179], v[136:139]
    v_cvt_pk_bf16_f32 v192, v116, v117
    v_cvt_pk_bf16_f32 v193, v118, v119
    v_cvt_pk_bf16_f32 v194, v120, v121
    v_cvt_pk_bf16_f32 v195, v122, v123
    v_cvt_pk_bf16_f32 v196, v124, v125
    v_cvt_pk_bf16_f32 v197, v126, v127
    v_cvt_pk_bf16_f32 v198, v128, v129
    v_cvt_pk_bf16_f32 v199, v130, v131
    ds_write_b64 v13, v[192:193] offset:256
    ds_write_b64 v13, v[194:195] offset:768
    ds_write_b64 v13, v[196:197] offset:1280
    ds_write_b64 v13, v[198:199] offset:1792
    v_mfma_f32_16x16x32_bf16 v[48:51], v[32:35], v[176:179], 0
    v_cvt_pk_bf16_f32 v4, v44, v45
    v_cvt_pk_bf16_f32 v5, v46, v47
    s_waitcnt lgkmcnt(15)
    v_mfma_f32_16x16x32_bf16 v[132:135], v[76:79], v[148:151], v[132:135]
    ds_write_b64 v11, v[4:5] offset:6272
    v_mfma_f32_16x16x32_bf16 v[136:139], v[108:111], v[148:151], v[136:139]
    ds_read_b128 v[148:151], v10 offset:18144
    v_mfma_f32_16x16x32_bf16 v[52:55], v[36:39], v[176:179], 0
    v_mfma_f32_16x16x32_bf16 v[132:135], v[72:75], v[152:155], v[132:135]
    v_cvt_pk_bf16_f32 v6, v48, v49
    v_cvt_pk_bf16_f32 v7, v50, v51
    v_mfma_f32_16x16x32_bf16 v[136:139], v[104:107], v[152:155], v[136:139]
    ds_write_b64 v11, v[6:7] offset:9568
    s_waitcnt lgkmcnt(15)
    v_mfma_f32_16x16x32_bf16 v[132:135], v[184:187], a[4:7], v[132:135]
    v_mfma_f32_16x16x32_bf16 v[136:139], v[184:187], a[12:15], v[136:139]
    v_cvt_pk_bf16_f32 v4, v52, v53
    v_cvt_pk_bf16_f32 v5, v54, v55
    v_mfma_f32_16x16x32_bf16 v[140:143], v[184:187], a[20:23], v[140:143]
    ds_write_b64 v11, v[4:5] offset:12864
    v_mfma_f32_16x16x32_bf16 v[44:47], v[40:43], v[176:179], 0
    ds_read_b64_tr_b16 v[184:185], v19 offset:544
    ds_read_b64_tr_b16 v[186:187], v20 offset:544
    v_mfma_f32_16x16x32_bf16 v[132:135], v[68:71], v[156:159], v[132:135]
    ds_read_b128 v[152:155], v10 offset:18208
    v_mfma_f32_16x16x32_bf16 v[136:139], v[100:103], v[156:159], v[136:139]
    ds_read_b128 v[176:179], v10 offset:18272
    s_waitcnt lgkmcnt(15)
    v_mfma_f32_16x16x32_bf16 v[132:135], v[64:67], v[160:163], v[132:135]
    s_waitcnt lgkmcnt(4)
    s_barrier
    ds_read_b64_tr_b16 v[192:193], v14 offset:256
    ds_read_b64_tr_b16 v[194:195], v14 offset:288
    ds_read_b64_tr_b16 v[196:197], v14 offset:320
    ds_read_b64_tr_b16 v[198:199], v14 offset:352
    v_mfma_f32_16x16x32_bf16 v[136:139], v[96:99], v[160:163], v[136:139]
    v_cvt_pk_bf16_f32 v6, v44, v45
    v_cvt_pk_bf16_f32 v7, v46, v47
    v_mfma_f32_16x16x32_bf16 v[132:135], v[188:191], a[24:27], v[132:135]
    ds_write_b64 v11, v[6:7] offset:15072
    v_mfma_f32_16x16x32_bf16 v[136:139], v[188:191], a[28:31], v[136:139]
    v_mfma_f32_16x16x32_bf16 v[140:143], v[188:191], a[32:35], v[140:143]
    v_mfma_f32_16x16x32_bf16 v[144:147], v[188:191], a[36:39], v[144:147]
    ds_read_b64_tr_b16 v[188:189], v19 offset:1088
    ds_read_b64_tr_b16 v[190:191], v20 offset:1088
    v_mfma_f32_16x16x32_bf16 v[132:135], v[60:63], v[164:167], v[132:135]
    ds_read_b128 v[156:159], v10 offset:18336
    v_mfma_f32_16x16x32_bf16 v[136:139], v[92:95], v[164:167], v[136:139]
    ds_read_b128 v[160:163], v10 offset:18400
    v_mfma_f32_16x16x32_bf16 v[132:135], v[56:59], v[168:171], v[132:135]
    v_mfma_f32_16x16x32_bf16 v[136:139], v[88:91], v[168:171], v[136:139]
    s_waitcnt lgkmcnt(15)
    v_mfma_f32_16x16x32_bf16 v[132:135], v[180:183], a[0:3], v[132:135]
    v_mfma_f32_16x16x32_bf16 v[136:139], v[180:183], a[8:11], v[136:139]
    v_mfma_f32_16x16x32_bf16 v[140:143], v[180:183], a[16:19], v[140:143]
    ds_read_b64_tr_b16 v[180:181], v17 offset:1632
    ds_read_b64_tr_b16 v[182:183], v18 offset:1632
    v_mfma_f32_16x16x32_bf16 v[132:135], a[44:47], v[172:175], v[132:135]
    ds_read_b128 v[164:167], v10 offset:18464
    v_mfma_f32_16x16x32_bf16 v[136:139], v[84:87], v[172:175], v[136:139]
    ds_read_b128 v[168:171], v10 offset:18528
    s_waitcnt lgkmcnt(8)
    v_mfma_f32_16x16x32_bf16 v[48:51], v[28:31], v[148:151], 0
    v_mfma_f32_16x16x32_bf16 v[132:135], a[40:43], v[148:151], v[132:135]
    v_mfma_f32_16x16x32_bf16 v[136:139], v[80:83], v[148:151], v[136:139]
    v_mfma_f32_16x16x32_bf16 v[140:143], v[112:115], v[148:151], v[140:143]
    s_waitcnt lgkmcnt(15)
    v_mfma_f32_16x16x32_bf16 v[136:139], v[184:187], a[24:27], v[136:139]
    s_nop 2
    v_cvt_pk_bf16_f32 v4, v48, v49
    v_cvt_pk_bf16_f32 v5, v50, v51
    v_mfma_f32_16x16x32_bf16 v[140:143], v[184:187], a[28:31], v[140:143]
    ds_write_b64 v11, v[4:5] offset:6816
    v_mfma_f32_16x16x32_bf16 v[144:147], v[184:187], a[32:35], v[144:147]
    ds_read_b64_tr_b16 v[184:185], v17 offset:1904
    ds_read_b64_tr_b16 v[186:187], v18 offset:1904
    v_mfma_f32_16x16x32_bf16 v[52:55], v[32:35], v[148:151], 0
    ds_read_b128 v[172:175], v10 offset:18592
    s_waitcnt lgkmcnt(15)
    v_mfma_f32_16x16x32_bf16 v[136:139], v[76:79], v[152:155], v[136:139]
    ds_read_b128 v[148:151], v10 offset:18656
    v_mfma_f32_16x16x32_bf16 v[140:143], v[108:111], v[152:155], v[140:143]
    v_mfma_f32_16x16x32_bf16 v[136:139], v[72:75], v[176:179], v[136:139]
    v_mfma_f32_16x16x32_bf16 v[140:143], v[104:107], v[176:179], v[140:143]
    s_nop 0
    v_cvt_pk_bf16_f32 v6, v52, v53
    v_cvt_pk_bf16_f32 v7, v54, v55
    s_waitcnt lgkmcnt(11)
    v_mfma_f32_16x16x32_bf16 v[140:143], v[188:191], a[24:27], v[140:143]
    v_bfi_b32 v192, v12, v192, v8
    v_bfi_b32 v193, v12, v193, v9
    buffer_store_dwordx2 v[192:193], v15, s[52:55], s51 offen offset:0 sc1
    v_mfma_f32_16x16x32_bf16 v[144:147], v[188:191], a[28:31], v[144:147]
    ds_write_b64 v11, v[6:7] offset:10112
    s_waitcnt lgkmcnt(11)
    v_mfma_f32_16x16x32_bf16 v[136:139], v[68:71], v[156:159], v[136:139]
    ds_read_b64_tr_b16 v[188:189], v19 offset:1632
    ds_read_b64_tr_b16 v[190:191], v20 offset:1632
    v_mfma_f32_16x16x32_bf16 v[140:143], v[100:103], v[156:159], v[140:143]
    ds_read_b128 v[152:155], v10 offset:18720
    s_waitcnt lgkmcnt(13)
    v_mfma_f32_16x16x32_bf16 v[136:139], v[64:67], v[160:163], v[136:139]
    ds_read_b128 v[176:179], v10 offset:18784
    v_mfma_f32_16x16x32_bf16 v[140:143], v[96:99], v[160:163], v[140:143]
    s_waitcnt lgkmcnt(12)
    v_mfma_f32_16x16x32_bf16 v[136:139], v[180:183], a[4:7], v[136:139]
    v_mfma_f32_16x16x32_bf16 v[140:143], v[180:183], a[12:15], v[140:143]
    v_mfma_f32_16x16x32_bf16 v[144:147], v[180:183], a[20:23], v[144:147]
    ds_read_b64_tr_b16 v[180:181], v17 offset:2176
    ds_read_b64_tr_b16 v[182:183], v18 offset:2176
    s_waitcnt lgkmcnt(13)
    v_mfma_f32_16x16x32_bf16 v[136:139], v[60:63], v[164:167], v[136:139]
    ds_read_b128 v[156:159], v10 offset:18848
    v_mfma_f32_16x16x32_bf16 v[140:143], v[92:95], v[164:167], v[140:143]
    ds_read_b128 v[160:163], v10 offset:18912
    s_waitcnt lgkmcnt(14)
    v_mfma_f32_16x16x32_bf16 v[136:139], v[56:59], v[168:171], v[136:139]
    v_mfma_f32_16x16x32_bf16 v[140:143], v[88:91], v[168:171], v[140:143]
    s_waitcnt lgkmcnt(11)
    v_mfma_f32_16x16x32_bf16 v[136:139], v[184:187], a[0:3], v[136:139]
    v_bfi_b32 v194, v12, v194, v8
    v_bfi_b32 v195, v12, v195, v9
    buffer_store_dwordx2 v[194:195], v15, s[52:55], s51 offen offset:128 sc1
    v_mfma_f32_16x16x32_bf16 v[140:143], v[184:187], a[8:11], v[140:143]
    v_mfma_f32_16x16x32_bf16 v[144:147], v[184:187], a[16:19], v[144:147]
    ds_read_b64_tr_b16 v[184:185], v17 offset:2448
    ds_read_b64_tr_b16 v[186:187], v18 offset:2448
    s_waitcnt lgkmcnt(12)
    v_mfma_f32_16x16x32_bf16 v[136:139], a[44:47], v[172:175], v[136:139]
    ds_read_b128 v[164:167], v10 offset:18976
    v_mfma_f32_16x16x32_bf16 v[140:143], v[84:87], v[172:175], v[140:143]
    ds_read_b128 v[168:171], v10 offset:19040
    s_waitcnt lgkmcnt(13)
    v_mfma_f32_16x16x32_bf16 v[44:47], v[28:31], v[148:151], 0
    ds_read_b128 v[172:175], v10 offset:19104
    v_mfma_f32_16x16x32_bf16 v[136:139], a[40:43], v[148:151], v[136:139]
    v_mfma_f32_16x16x32_bf16 v[140:143], v[80:83], v[148:151], v[140:143]
    v_mfma_f32_16x16x32_bf16 v[144:147], v[112:115], v[148:151], v[144:147]
    s_waitcnt lgkmcnt(11)
    v_mfma_f32_16x16x32_bf16 v[144:147], v[188:191], a[24:27], v[144:147]
    s_nop 1
    v_cvt_pk_bf16_f32 v4, v44, v45
    v_cvt_pk_bf16_f32 v5, v46, v47
    v_mfma_f32_16x16x32_bf16 v[48:51], v[32:35], v[148:151], 0
    ds_write_b64 v11, v[4:5] offset:7360
    s_waitcnt lgkmcnt(11)
    v_mfma_f32_16x16x32_bf16 v[140:143], v[76:79], v[152:155], v[140:143]
    v_mfma_f32_16x16x32_bf16 v[144:147], v[108:111], v[152:155], v[144:147]
    s_waitcnt lgkmcnt(10)
    v_mfma_f32_16x16x32_bf16 v[140:143], v[72:75], v[176:179], v[140:143]
    v_bfi_b32 v196, v12, v196, v8
    v_bfi_b32 v197, v12, v197, v9
    buffer_store_dwordx2 v[196:197], v15, s[52:55], s51 offen offset:256 sc1
    v_mfma_f32_16x16x32_bf16 v[144:147], v[104:107], v[176:179], v[144:147]
    v_cvt_pk_bf16_f32 v6, v48, v49
    v_cvt_pk_bf16_f32 v7, v50, v51
    s_waitcnt lgkmcnt(8)
    v_mfma_f32_16x16x32_bf16 v[140:143], v[180:183], a[4:7], v[140:143]
    ds_write_b64 v11, v[6:7] offset:10656
    v_mfma_f32_16x16x32_bf16 v[144:147], v[180:183], a[12:15], v[144:147]
    ds_read_b64_tr_b16 v[188:189], v17 offset:2720
    ds_read_b64_tr_b16 v[190:191], v18 offset:2720
    s_waitcnt lgkmcnt(10)
    v_mfma_f32_16x16x32_bf16 v[140:143], v[68:71], v[156:159], v[140:143]
    ds_read_b128 v[148:151], v10 offset:19168
    v_mfma_f32_16x16x32_bf16 v[144:147], v[100:103], v[156:159], v[144:147]
    ds_read_b128 v[152:155], v10 offset:19232
    s_waitcnt lgkmcnt(11)
    v_mfma_f32_16x16x32_bf16 v[140:143], v[64:67], v[160:163], v[140:143]
    ds_read_b64_tr_b16 v[180:181], v17 offset:2992
    ds_read_b64_tr_b16 v[182:183], v18 offset:2992
    v_mfma_f32_16x16x32_bf16 v[144:147], v[96:99], v[160:163], v[144:147]
    ds_read_b128 v[176:179], v10 offset:19296
    s_waitcnt lgkmcnt(12)
    v_mfma_f32_16x16x32_bf16 v[140:143], v[184:187], a[0:3], v[140:143]
    ds_read_b128 v[156:159], v10 offset:19360
    v_mfma_f32_16x16x32_bf16 v[144:147], v[184:187], a[8:11], v[144:147]
    ds_read_b128 v[160:163], v10 offset:19424
    s_waitcnt lgkmcnt(13)
    v_mfma_f32_16x16x32_bf16 v[140:143], v[60:63], v[164:167], v[140:143]
    v_mfma_f32_16x16x32_bf16 v[144:147], v[92:95], v[164:167], v[144:147]
    ds_read_b128 v[164:167], v10 offset:19488
    s_waitcnt lgkmcnt(13)
    v_mfma_f32_16x16x32_bf16 v[140:143], v[56:59], v[168:171], v[140:143]
    v_mfma_f32_16x16x32_bf16 v[144:147], v[88:91], v[168:171], v[144:147]
    v_bfi_b32 v198, v12, v198, v8
    v_bfi_b32 v199, v12, v199, v9
    buffer_store_dwordx2 v[198:199], v15, s[52:55], s51 offen offset:384 sc1
    s_waitcnt lgkmcnt(12)
    v_mfma_f32_16x16x32_bf16 v[140:143], a[44:47], v[172:175], v[140:143]
    ds_read_b128 v[168:171], v10 offset:19552
    v_mfma_f32_16x16x32_bf16 v[144:147], v[84:87], v[172:175], v[144:147]
    ds_read_b128 v[172:175], v10 offset:19616
    s_waitcnt lgkmcnt(10)
    v_mfma_f32_16x16x32_bf16 v[144:147], v[188:191], a[4:7], v[144:147]
    s_waitcnt lgkmcnt(9)
    v_mfma_f32_16x16x32_bf16 v[140:143], a[40:43], v[148:151], v[140:143]
    v_mfma_f32_16x16x32_bf16 v[144:147], v[80:83], v[148:151], v[144:147]
    ds_read_b128 v[148:151], v10 offset:19680
    s_waitcnt lgkmcnt(9)
    v_mfma_f32_16x16x32_bf16 v[144:147], v[76:79], v[152:155], v[144:147]
    s_waitcnt lgkmcnt(7)
    v_mfma_f32_16x16x32_bf16 v[144:147], v[180:183], a[0:3], v[144:147]
    s_waitcnt lgkmcnt(6)
    v_mfma_f32_16x16x32_bf16 v[144:147], v[72:75], v[176:179], v[144:147]
    s_waitcnt lgkmcnt(5)
    v_mfma_f32_16x16x32_bf16 v[144:147], v[68:71], v[156:159], v[144:147]
    s_waitcnt lgkmcnt(4)
    v_mfma_f32_16x16x32_bf16 v[144:147], v[64:67], v[160:163], v[144:147]
    s_waitcnt lgkmcnt(3)
    v_mfma_f32_16x16x32_bf16 v[144:147], v[60:63], v[164:167], v[144:147]
    s_waitcnt lgkmcnt(2)
    v_mfma_f32_16x16x32_bf16 v[144:147], v[56:59], v[168:171], v[144:147]
    s_waitcnt lgkmcnt(1)
    v_mfma_f32_16x16x32_bf16 v[144:147], a[44:47], v[172:175], v[144:147]
    s_waitcnt lgkmcnt(0)
    v_mfma_f32_16x16x32_bf16 v[144:147], a[40:43], v[148:151], v[144:147]
    v_cvt_pk_bf16_f32 v192, v132, v133
    v_cvt_pk_bf16_f32 v193, v134, v135
    v_cvt_pk_bf16_f32 v194, v136, v137
    v_cvt_pk_bf16_f32 v195, v138, v139
    v_cvt_pk_bf16_f32 v196, v140, v141
    v_cvt_pk_bf16_f32 v197, v142, v143
    s_nop 1
    v_cvt_pk_bf16_f32 v198, v144, v145
    v_cvt_pk_bf16_f32 v199, v146, v147
    ds_write_b64 v13, v[192:193] offset:2304
    ds_write_b64 v13, v[194:195] offset:2816
    ds_write_b64 v13, v[196:197] offset:3328
    ds_write_b64 v13, v[198:199] offset:3840
    s_waitcnt lgkmcnt(0)
    s_barrier
    ds_read_b64_tr_b16 v[192:193], v14 offset:2304
    ds_read_b64_tr_b16 v[194:195], v14 offset:2336
    ds_read_b64_tr_b16 v[196:197], v14 offset:2368
    ds_read_b64_tr_b16 v[198:199], v14 offset:2400
    s_waitcnt lgkmcnt(0)
    v_bfi_b32 v192, v12, v192, v8
    v_bfi_b32 v193, v12, v193, v9
    buffer_store_dwordx2 v[192:193], v15, s[52:55], s56 offen offset:0 sc1
    v_bfi_b32 v194, v12, v194, v8
    v_bfi_b32 v195, v12, v195, v9
    buffer_store_dwordx2 v[194:195], v15, s[52:55], s56 offen offset:128 sc1
    v_bfi_b32 v196, v12, v196, v8
    v_bfi_b32 v197, v12, v197, v9
    buffer_store_dwordx2 v[196:197], v15, s[52:55], s56 offen offset:256 sc1
    v_bfi_b32 v198, v12, v198, v8
    v_bfi_b32 v199, v12, v199, v9
    buffer_store_dwordx2 v[198:199], v15, s[52:55], s56 offen offset:384 sc1
L_end:
    s_endpgm
Lsp1:
    s_waitcnt vmcnt(4)
    s_lshl2_add_u32 s12, s34, s32
    s_lshl_b32 s12, s12, 12
    s_add_u32 s12, s12, 21037056
    buffer_load_dwordx4 v[82:85], v2, s[48:51], s12 offen offset:0 sc1
    buffer_load_dwordx4 v[86:89], v2, s[48:51], s12 offen offset:1024 sc1
    buffer_load_dwordx4 v[90:93], v2, s[48:51], s12 offen offset:2048 sc1
    buffer_load_dwordx4 v[94:97], v2, s[48:51], s12 offen offset:3072 sc1
    s_add_u32 s13, s57, 0
    buffer_load_dwordx4 v[66:69], v10, s[64:67], s13 offen
    s_add_u32 s13, s57, 65664
    buffer_load_dwordx4 v[70:73], v10, s[64:67], s13 offen
    s_add_u32 s13, s57, 131328
    buffer_load_dwordx4 v[74:77], v10, s[64:67], s13 offen
    s_add_u32 s13, s57, 196992
    buffer_load_dwordx4 v[78:81], v10, s[64:67], s13 offen
    s_waitcnt vmcnt(4)
    v_bitop3_b32 v5, v83, v85, s58 bitop3:0x7e
    v_bitop3_b32 v8, v87, v89, s58 bitop3:0x7e
    v_or_b32 v5, v8, v5
    v_bitop3_b32 v8, v91, v93, s58 bitop3:0x7e
    v_or_b32 v5, v8, v5
    v_bitop3_b32 v8, v95, v97, s58 bitop3:0x7e
    v_or_b32 v5, v8, v5
    v_cmp_ne_u32 vcc, 0, v5
    s_cbranch_vccnz Lre5
Lok4:
    v_and_b32 v8, 3, v1
    v_lshrrev_b32 v9, 2, v1
    v_lshlrev_b32 v9, 3, v9
    v_lshl_add_u32 v8, v8, 11, v9
    s_lshl_b32 s12, s32, 9
    s_add_u32 s12, s12, 51200
    v_add_u32 v8, s12, v8
    ds_write2_b32 v8, v82, v84 offset0:0 offset1:1
    ds_write2_b32 v8, v86, v88 offset0:32 offset1:33
    ds_write2_b32 v8, v90, v92 offset0:64 offset1:65
    ds_write2_b32 v8, v94, v96 offset0:96 offset1:97
    s_waitcnt vmcnt(8)
    s_sleep 16
    buffer_load_dwordx4 v[50:53], v2, s[48:51], s56 offen offset:0 sc1
    buffer_load_dwordx4 v[54:57], v2, s[48:51], s56 offen offset:1024 sc1
    buffer_load_dwordx4 v[58:61], v2, s[48:51], s56 offen offset:2048 sc1
    buffer_load_dwordx4 v[62:65], v2, s[48:51], s56 offen offset:3072 sc1
    s_lshl_b32 s12, s34, 14
    s_add_u32 s12, s12, 20971520
    v_lshrrev_b32 v7, 4, v1
    v_and_b32 v8, 15, v1
    v_lshl_add_u32 v7, v7, 6, v8
    v_lshlrev_b32 v9, 6, v7
    s_cmp_eq_u32 s32, 0
    s_cselect_b64 exec, -1, 1
    buffer_load_dwordx4 v[122:125], v9, s[48:51], s12 offen offset:0 sc1
    buffer_load_dwordx4 v[126:129], v9, s[48:51], s12 offen offset:1024 sc1
    buffer_load_dwordx4 v[146:149], v9, s[48:51], s12 offen offset:2048 sc1
    buffer_load_dwordx4 v[150:153], v9, s[48:51], s12 offen offset:3072 sc1
    s_mov_b64 exec, -1
    s_waitcnt vmcnt(8)
    s_lshl_b32 s36, s32, 10
    s_add_u32 m0, s36, 0
    s_nop 0
    ds_write_addtid_b32 v66 offset:0
    ds_write_addtid_b32 v67 offset:4096
    ds_write_addtid_b32 v68 offset:8192
    ds_write_addtid_b32 v69 offset:12288
    ds_write_addtid_b32 v70 offset:256
    ds_write_addtid_b32 v71 offset:4352
    ds_write_addtid_b32 v72 offset:8448
    ds_write_addtid_b32 v73 offset:12544
    ds_write_addtid_b32 v74 offset:512
    ds_write_addtid_b32 v75 offset:4608
    ds_write_addtid_b32 v76 offset:8704
    ds_write_addtid_b32 v77 offset:12800
    ds_write_addtid_b32 v78 offset:768
    ds_write_addtid_b32 v79 offset:4864
    ds_write_addtid_b32 v80 offset:8960
    ds_write_addtid_b32 v81 offset:13056
    s_waitcnt lgkmcnt(0)
    s_barrier
    ds_read2st64_b32 v[66:67], v19 offset0:0 offset1:1
    ds_read2st64_b32 v[68:69], v19 offset0:2 offset1:3
    ds_read2st64_b32 v[70:71], v19 offset0:4 offset1:5
    ds_read2st64_b32 v[72:73], v19 offset0:6 offset1:7
    ds_read2st64_b32 v[74:75], v19 offset0:8 offset1:9
    ds_read2st64_b32 v[76:77], v19 offset0:10 offset1:11
    ds_read2st64_b32 v[78:79], v19 offset0:12 offset1:13
    ds_read2st64_b32 v[80:81], v19 offset0:14 offset1:15
    v_lshlrev_b32 v5, 3, v7
    ds_read_b64 v[130:131], v5 offset:51200
    ds_read_b64 v[132:133], v5 offset:51328
    ds_read_b64 v[134:135], v5 offset:51456
    ds_read_b64 v[136:137], v5 offset:51584
    ds_read_b64 v[138:139], v5 offset:53248
    ds_read_b64 v[140:141], v5 offset:53376
    ds_read_b64 v[142:143], v5 offset:53504
    ds_read_b64 v[144:145], v5 offset:53632
    s_waitcnt lgkmcnt(8)
    v_and_b32 v106, 0xffff0000, v66
    v_and_b32 v107, 0xffff0000, v67
    v_and_b32 v108, 0xffff0000, v68
    v_and_b32 v109, 0xffff0000, v69
    v_and_b32 v110, 0xffff0000, v70
    v_and_b32 v111, 0xffff0000, v71
    v_and_b32 v112, 0xffff0000, v72
    v_and_b32 v113, 0xffff0000, v73
    v_and_b32 v114, 0xffff0000, v74
    v_and_b32 v115, 0xffff0000, v75
    v_and_b32 v116, 0xffff0000, v76
    v_and_b32 v117, 0xffff0000, v77
    v_and_b32 v118, 0xffff0000, v78
    v_and_b32 v119, 0xffff0000, v79
    v_and_b32 v120, 0xffff0000, v80
    v_and_b32 v121, 0xffff0000, v81
    v_pk_add_f32 v[186:187], v[106:107], v[114:115] neg_lo:[0,1] neg_hi:[0,1]
    v_pk_add_f32 v[106:107], v[106:107], v[114:115]
    v_pk_add_f32 v[190:191], v[110:111], v[118:119] neg_lo:[0,1] neg_hi:[0,1]
    v_pk_add_f32 v[110:111], v[110:111], v[118:119]
    v_pk_fma_f32 v[170:171], v[30:31], v[186:187], v[106:107] neg_lo:[1,0,0] neg_hi:[1,0,0]
    v_pk_fma_f32 v[178:179], v[30:31], v[186:187], v[106:107]
    v_pk_fma_f32 v[174:175], v[30:31], v[190:191], v[110:111] neg_lo:[1,0,0] neg_hi:[1,0,0]
    v_pk_fma_f32 v[182:183], v[30:31], v[190:191], v[110:111]
    v_pk_mul_f32 v[186:187], v[34:35], v[186:187]
    v_pk_mul_f32 v[190:191], v[34:35], v[190:191]
    v_pk_add_f32 v[188:189], v[108:109], v[116:117] neg_lo:[0,1] neg_hi:[0,1]
    v_pk_add_f32 v[108:109], v[108:109], v[116:117]
    v_pk_add_f32 v[192:193], v[112:113], v[120:121] neg_lo:[0,1] neg_hi:[0,1]
    v_pk_add_f32 v[112:113], v[112:113], v[120:121]
    v_pk_fma_f32 v[172:173], v[32:33], v[188:189], v[108:109] neg_lo:[1,0,0] neg_hi:[1,0,0]
    v_pk_fma_f32 v[180:181], v[32:33], v[188:189], v[108:109]
    v_pk_fma_f32 v[176:177], v[32:33], v[192:193], v[112:113] neg_lo:[1,0,0] neg_hi:[1,0,0]
    v_pk_fma_f32 v[184:185], v[32:33], v[192:193], v[112:113]
    v_pk_mul_f32 v[188:189], v[36:37], v[188:189]
    v_pk_mul_f32 v[192:193], v[36:37], v[192:193]
    s_cmp_eq_u32 s32, 0
    s_cbranch_scc1 Lw07
    v_lshlrev_b32 v106, 16, v66
    v_lshlrev_b32 v107, 16, v67
    v_lshlrev_b32 v108, 16, v68
    v_lshlrev_b32 v109, 16, v69
    v_lshlrev_b32 v110, 16, v70
    v_lshlrev_b32 v111, 16, v71
    v_lshlrev_b32 v112, 16, v72
    v_lshlrev_b32 v113, 16, v73
    v_lshlrev_b32 v114, 16, v74
    v_lshlrev_b32 v115, 16, v75
    v_lshlrev_b32 v116, 16, v76
    v_lshlrev_b32 v117, 16, v77
    v_lshlrev_b32 v118, 16, v78
    v_lshlrev_b32 v119, 16, v79
    v_lshlrev_b32 v120, 16, v80
    v_lshlrev_b32 v121, 16, v81
    v_pk_add_f32 v[162:163], v[106:107], v[114:115] neg_lo:[0,1] neg_hi:[0,1]
    v_pk_add_f32 v[106:107], v[106:107], v[114:115]
    v_pk_add_f32 v[166:167], v[110:111], v[118:119] neg_lo:[0,1] neg_hi:[0,1]
    v_pk_add_f32 v[110:111], v[110:111], v[118:119]
    v_pk_fma_f32 v[38:39], v[30:31], v[162:163], v[106:107] neg_lo:[1,0,0] neg_hi:[1,0,0]
    v_pk_fma_f32 v[154:155], v[30:31], v[162:163], v[106:107]
    v_pk_fma_f32 v[42:43], v[30:31], v[166:167], v[110:111] neg_lo:[1,0,0] neg_hi:[1,0,0]
    v_pk_fma_f32 v[158:159], v[30:31], v[166:167], v[110:111]
    v_pk_mul_f32 v[162:163], v[34:35], v[162:163]
    v_pk_mul_f32 v[166:167], v[34:35], v[166:167]
    v_pk_add_f32 v[164:165], v[108:109], v[116:117] neg_lo:[0,1] neg_hi:[0,1]
    v_pk_add_f32 v[108:109], v[108:109], v[116:117]
    v_pk_add_f32 v[168:169], v[112:113], v[120:121] neg_lo:[0,1] neg_hi:[0,1]
    v_pk_add_f32 v[112:113], v[112:113], v[120:121]
    v_pk_fma_f32 v[40:41], v[32:33], v[164:165], v[108:109] neg_lo:[1,0,0] neg_hi:[1,0,0]
    v_pk_fma_f32 v[156:157], v[32:33], v[164:165], v[108:109]
    v_pk_fma_f32 v[44:45], v[32:33], v[168:169], v[112:113] neg_lo:[1,0,0] neg_hi:[1,0,0]
    v_pk_fma_f32 v[160:161], v[32:33], v[168:169], v[112:113]
    v_pk_mul_f32 v[164:165], v[36:37], v[164:165]
    v_pk_mul_f32 v[168:169], v[36:37], v[168:169]
    s_branch Lw18
Lw07:
    s_waitcnt lgkmcnt(0)
    v_lshlrev_b32 v106, 16, v130
    v_and_b32 v110, 0xffff0000, v130
    v_lshlrev_b32 v107, 16, v132
    v_and_b32 v111, 0xffff0000, v132
    v_lshlrev_b32 v108, 16, v134
    v_and_b32 v112, 0xffff0000, v134
    v_lshlrev_b32 v109, 16, v136
    v_and_b32 v113, 0xffff0000, v136
    v_lshlrev_b32 v114, 16, v131
    v_and_b32 v118, 0xffff0000, v131
    v_lshlrev_b32 v115, 16, v133
    v_and_b32 v119, 0xffff0000, v133
    v_lshlrev_b32 v116, 16, v135
    v_and_b32 v120, 0xffff0000, v135
    v_lshlrev_b32 v117, 16, v137
    v_and_b32 v121, 0xffff0000, v137
    v_pk_add_f32 v[162:163], v[106:107], v[114:115] neg_lo:[0,1] neg_hi:[0,1]
    v_pk_add_f32 v[106:107], v[106:107], v[114:115]
    v_pk_add_f32 v[166:167], v[110:111], v[118:119] neg_lo:[0,1] neg_hi:[0,1]
    v_pk_add_f32 v[110:111], v[110:111], v[118:119]
    v_pk_fma_f32 v[38:39], v[30:31], v[162:163], v[106:107] neg_lo:[1,0,0] neg_hi:[1,0,0]
    v_pk_fma_f32 v[82:83], v[30:31], v[162:163], v[106:107]
    v_pk_fma_f32 v[42:43], v[30:31], v[166:167], v[110:111] neg_lo:[1,0,0] neg_hi:[1,0,0]
    v_pk_fma_f32 v[86:87], v[30:31], v[166:167], v[110:111]
    v_pk_mul_f32 v[162:163], v[34:35], v[162:163]
    v_pk_mul_f32 v[166:167], v[34:35], v[166:167]
    v_pk_add_f32 v[164:165], v[108:109], v[116:117] neg_lo:[0,1] neg_hi:[0,1]
    v_pk_add_f32 v[108:109], v[108:109], v[116:117]
    v_pk_add_f32 v[168:169], v[112:113], v[120:121] neg_lo:[0,1] neg_hi:[0,1]
    v_pk_add_f32 v[112:113], v[112:113], v[120:121]
    v_pk_fma_f32 v[40:41], v[32:33], v[164:165], v[108:109] neg_lo:[1,0,0] neg_hi:[1,0,0]
    v_pk_fma_f32 v[84:85], v[32:33], v[164:165], v[108:109]
    v_pk_fma_f32 v[44:45], v[32:33], v[168:169], v[112:113] neg_lo:[1,0,0] neg_hi:[1,0,0]
    v_pk_fma_f32 v[88:89], v[32:33], v[168:169], v[112:113]
    v_pk_mul_f32 v[164:165], v[36:37], v[164:165]
    v_pk_mul_f32 v[168:169], v[36:37], v[168:169]
    v_lshlrev_b32 v106, 16, v138
    v_and_b32 v110, 0xffff0000, v138
    v_lshlrev_b32 v107, 16, v140
    v_and_b32 v111, 0xffff0000, v140
    v_lshlrev_b32 v108, 16, v142
    v_and_b32 v112, 0xffff0000, v142
    v_lshlrev_b32 v109, 16, v144
    v_and_b32 v113, 0xffff0000, v144
    v_lshlrev_b32 v114, 16, v139
    v_and_b32 v118, 0xffff0000, v139
    v_lshlrev_b32 v115, 16, v141
    v_and_b32 v119, 0xffff0000, v141
    v_lshlrev_b32 v116, 16, v143
    v_and_b32 v120, 0xffff0000, v143
    v_lshlrev_b32 v117, 16, v145
    v_and_b32 v121, 0xffff0000, v145
    v_pk_add_f32 v[66:67], v[106:107], v[114:115] neg_lo:[0,1] neg_hi:[0,1]
    v_pk_add_f32 v[106:107], v[106:107], v[114:115]
    v_pk_add_f32 v[70:71], v[110:111], v[118:119] neg_lo:[0,1] neg_hi:[0,1]
    v_pk_add_f32 v[110:111], v[110:111], v[118:119]
    v_pk_fma_f32 v[82:83], v[30:31], v[66:67], v[106:107] neg_lo:[1,0,0] neg_hi:[1,0,0]
    v_pk_fma_f32 v[154:155], v[30:31], v[66:67], v[106:107]
    v_pk_fma_f32 v[86:87], v[30:31], v[70:71], v[110:111] neg_lo:[1,0,0] neg_hi:[1,0,0]
    v_pk_fma_f32 v[158:159], v[30:31], v[70:71], v[110:111]
    v_pk_mul_f32 v[66:67], v[34:35], v[66:67]
    v_pk_mul_f32 v[70:71], v[34:35], v[70:71]
    v_pk_add_f32 v[68:69], v[108:109], v[116:117] neg_lo:[0,1] neg_hi:[0,1]
    v_pk_add_f32 v[108:109], v[108:109], v[116:117]
    v_pk_add_f32 v[72:73], v[112:113], v[120:121] neg_lo:[0,1] neg_hi:[0,1]
    v_pk_add_f32 v[112:113], v[112:113], v[120:121]
    v_pk_fma_f32 v[84:85], v[32:33], v[68:69], v[108:109] neg_lo:[1,0,0] neg_hi:[1,0,0]
    v_pk_fma_f32 v[156:157], v[32:33], v[68:69], v[108:109]
    v_pk_fma_f32 v[88:89], v[32:33], v[72:73], v[112:113] neg_lo:[1,0,0] neg_hi:[1,0,0]
    v_pk_fma_f32 v[160:161], v[32:33], v[72:73], v[112:113]
    v_pk_mul_f32 v[68:69], v[36:37], v[68:69]
    v_pk_mul_f32 v[72:73], v[36:37], v[72:73]
Lw18:
    s_waitcnt lgkmcnt(0)
    s_waitcnt vmcnt(4)
    v_bitop3_b32 v8, v50, v54, s60 bitop3:0x7e
    v_bitop3_b32 v106, v58, v62, s60 bitop3:0x7e
    v_or3_b32 v5, v8, v106, 0
    v_bitop3_b32 v8, v51, v55, s61 bitop3:0x7e
    v_bitop3_b32 v106, v59, v63, s61 bitop3:0x7e
    v_or3_b32 v5, v8, v106, v5
    v_bitop3_b32 v8, v52, v56, s62 bitop3:0x7e
    v_bitop3_b32 v106, v60, v64, s62 bitop3:0x7e
    v_or3_b32 v5, v8, v106, v5
    v_bitop3_b32 v8, v53, v57, s63 bitop3:0x7e
    v_bitop3_b32 v106, v61, v65, s63 bitop3:0x7e
    v_or3_b32 v5, v8, v106, v5
    v_and_b32 v5, 0x10001, v5
    v_cmp_ne_u32 vcc, 0, v5
    s_cbranch_vccnz Lre10
Lok9:
    s_xor_b32 s61, s61, 1
    v_mov_b32 v82, v50
    v_mov_b32 v83, v54
    v_mov_b32 v84, v58
    v_mov_b32 v85, v62
    ds_write_b128 v14, v[82:85] offset:16384
    v_mov_b32 v86, v51
    v_mov_b32 v87, v55
    v_mov_b32 v88, v59
    v_mov_b32 v89, v63
    ds_write_b128 v14, v[86:89] offset:17408
    v_mov_b32 v90, v52
    v_mov_b32 v91, v56
    v_mov_b32 v92, v60
    v_mov_b32 v93, v64
    ds_write_b128 v14, v[90:93] offset:18432
    v_mov_b32 v94, v53
    v_mov_b32 v95, v57
    v_mov_b32 v96, v61
    v_mov_b32 v97, v65
    ds_write_b128 v14, v[94:97] offset:19456
    s_waitcnt lgkmcnt(0)
    s_barrier
    ds_read_b128 v[82:85], v15 offset:16384
    ds_read_b128 v[86:89], v15 offset:17408
    ds_read_b128 v[90:93], v15 offset:18432
    ds_read_b128 v[94:97], v15 offset:19456
    s_cmp_lg_u32 s32, 0
    s_cbranch_scc1 Ljs2
    s_waitcnt vmcnt(0)
    v_bitop3_b32 v5, v123, v125, s58 bitop3:0x7e
    v_bitop3_b32 v8, v127, v129, s58 bitop3:0x7e
    v_or_b32 v5, v8, v5
    v_bitop3_b32 v8, v147, v149, s58 bitop3:0x7e
    v_or_b32 v5, v8, v5
    v_bitop3_b32 v8, v151, v153, s58 bitop3:0x7e
    v_or_b32 v5, v8, v5
    v_cmp_ne_u32 vcc, 0, v5
    s_cbranch_vccnz Lre17
Lok16:
    s_cmp_lg_u32 s33, 0
    s_cbranch_scc1 Lep19
    s_add_u32 s36, s40, 1
    v_mov_b32 v5, s36
    v_mov_b32 v8, 0
    s_mov_b64 exec, 1
    global_store_dword v8, v5, s[42:43]
    s_mov_b64 exec, -1
    s_nop 0
Lep19:
    v_mov_b32 v98, v122
    v_mov_b32 v99, v126
    v_mov_b32 v100, v146
    v_mov_b32 v101, v150
    v_mov_b32 v102, v124
    v_mov_b32 v103, v128
    v_mov_b32 v104, v148
    v_mov_b32 v105, v152
    s_waitcnt lgkmcnt(3)
    v_mfma_f32_16x16x32_bf16 v[106:109], v[82:85], a[32:35], 0
    v_mfma_f32_16x16x32_bf16 v[130:133], v[82:85], a[36:39], 0
    s_waitcnt lgkmcnt(2)
    v_mfma_f32_16x16x32_bf16 v[110:113], v[86:89], a[32:35], 0
    v_mfma_f32_16x16x32_bf16 v[134:137], v[86:89], a[36:39], 0
    s_waitcnt lgkmcnt(1)
    v_mfma_f32_16x16x32_bf16 v[114:117], v[90:93], a[32:35], 0
    v_mfma_f32_16x16x32_bf16 v[138:141], v[90:93], a[36:39], 0
    s_waitcnt lgkmcnt(0)
    v_mfma_f32_16x16x32_bf16 v[118:121], v[94:97], a[32:35], 0
    v_mfma_f32_16x16x32_bf16 v[142:145], v[94:97], a[36:39], 0
    s_waitcnt lgkmcnt(0)
    v_mfma_f32_16x16x32_bf16 v[122:125], v[98:101], a[32:35], 0
    v_mfma_f32_16x16x32_bf16 v[146:149], v[98:101], a[36:39], 0
    s_waitcnt lgkmcnt(0)
    v_mfma_f32_16x16x32_bf16 v[126:129], v[102:105], a[32:35], 0
    v_mfma_f32_16x16x32_bf16 v[150:153], v[102:105], a[36:39], 0
    v_pk_mul_f32 v[194:195], v[106:107], v[22:23]
    v_pk_mul_f32 v[196:197], v[130:131], v[22:23]
    v_pk_mul_f32 v[198:199], v[108:109], v[24:25]
    v_pk_mul_f32 v[200:201], v[132:133], v[24:25]
    v_pk_fma_f32 v[194:195], v[130:131], v[26:27], v[194:195]
    v_pk_fma_f32 v[196:197], v[106:107], v[26:27], v[196:197] neg_lo:[1,0,0] neg_hi:[1,0,0]
    v_pk_fma_f32 v[198:199], v[132:133], v[28:29], v[198:199]
    v_pk_fma_f32 v[200:201], v[108:109], v[28:29], v[200:201] neg_lo:[1,0,0] neg_hi:[1,0,0]
    v_cvt_pk_bf16_f32 v82, v194, v196
    v_cvt_pk_bf16_f32 v83, v195, v197
    v_cvt_pk_bf16_f32 v84, v198, v200
    v_cvt_pk_bf16_f32 v85, v199, v201
    v_pk_mul_f32 v[194:195], v[110:111], v[22:23]
    v_pk_mul_f32 v[196:197], v[134:135], v[22:23]
    v_pk_mul_f32 v[198:199], v[112:113], v[24:25]
    v_pk_mul_f32 v[200:201], v[136:137], v[24:25]
    v_pk_fma_f32 v[194:195], v[134:135], v[26:27], v[194:195]
    v_pk_fma_f32 v[196:197], v[110:111], v[26:27], v[196:197] neg_lo:[1,0,0] neg_hi:[1,0,0]
    v_pk_fma_f32 v[198:199], v[136:137], v[28:29], v[198:199]
    v_pk_fma_f32 v[200:201], v[112:113], v[28:29], v[200:201] neg_lo:[1,0,0] neg_hi:[1,0,0]
    v_cvt_pk_bf16_f32 v86, v194, v196
    v_cvt_pk_bf16_f32 v87, v195, v197
    v_cvt_pk_bf16_f32 v88, v198, v200
    v_cvt_pk_bf16_f32 v89, v199, v201
    v_pk_mul_f32 v[194:195], v[114:115], v[22:23]
    v_pk_mul_f32 v[196:197], v[138:139], v[22:23]
    v_pk_mul_f32 v[198:199], v[116:117], v[24:25]
    v_pk_mul_f32 v[200:201], v[140:141], v[24:25]
    v_pk_fma_f32 v[194:195], v[138:139], v[26:27], v[194:195]
    v_pk_fma_f32 v[196:197], v[114:115], v[26:27], v[196:197] neg_lo:[1,0,0] neg_hi:[1,0,0]
    v_pk_fma_f32 v[198:199], v[140:141], v[28:29], v[198:199]
    v_pk_fma_f32 v[200:201], v[116:117], v[28:29], v[200:201] neg_lo:[1,0,0] neg_hi:[1,0,0]
    v_cvt_pk_bf16_f32 v90, v194, v196
    v_cvt_pk_bf16_f32 v91, v195, v197
    v_cvt_pk_bf16_f32 v92, v198, v200
    v_cvt_pk_bf16_f32 v93, v199, v201
    v_pk_mul_f32 v[194:195], v[118:119], v[22:23]
    v_pk_mul_f32 v[196:197], v[142:143], v[22:23]
    v_pk_mul_f32 v[198:199], v[120:121], v[24:25]
    v_pk_mul_f32 v[200:201], v[144:145], v[24:25]
    v_pk_fma_f32 v[194:195], v[142:143], v[26:27], v[194:195]
    v_pk_fma_f32 v[196:197], v[118:119], v[26:27], v[196:197] neg_lo:[1,0,0] neg_hi:[1,0,0]
    v_pk_fma_f32 v[198:199], v[144:145], v[28:29], v[198:199]
    v_pk_fma_f32 v[200:201], v[120:121], v[28:29], v[200:201] neg_lo:[1,0,0] neg_hi:[1,0,0]
    v_cvt_pk_bf16_f32 v94, v194, v196
    v_cvt_pk_bf16_f32 v95, v195, v197
    v_cvt_pk_bf16_f32 v96, v198, v200
    v_cvt_pk_bf16_f32 v97, v199, v201
    v_pk_mul_f32 v[194:195], v[122:123], v[22:23]
    v_pk_mul_f32 v[196:197], v[146:147], v[22:23]
    v_pk_mul_f32 v[198:199], v[124:125], v[24:25]
    v_pk_mul_f32 v[200:201], v[148:149], v[24:25]
    v_pk_fma_f32 v[194:195], v[146:147], v[26:27], v[194:195]
    v_pk_fma_f32 v[196:197], v[122:123], v[26:27], v[196:197] neg_lo:[1,0,0] neg_hi:[1,0,0]
    v_pk_fma_f32 v[198:199], v[148:149], v[28:29], v[198:199]
    v_pk_fma_f32 v[200:201], v[124:125], v[28:29], v[200:201] neg_lo:[1,0,0] neg_hi:[1,0,0]
    v_cvt_pk_bf16_f32 v98, v194, v196
    v_cvt_pk_bf16_f32 v99, v195, v197
    v_cvt_pk_bf16_f32 v100, v198, v200
    v_cvt_pk_bf16_f32 v101, v199, v201
    v_pk_mul_f32 v[194:195], v[126:127], v[22:23]
    v_pk_mul_f32 v[196:197], v[150:151], v[22:23]
    v_pk_mul_f32 v[198:199], v[128:129], v[24:25]
    v_pk_mul_f32 v[200:201], v[152:153], v[24:25]
    v_pk_fma_f32 v[194:195], v[150:151], v[26:27], v[194:195]
    v_pk_fma_f32 v[196:197], v[126:127], v[26:27], v[196:197] neg_lo:[1,0,0] neg_hi:[1,0,0]
    v_pk_fma_f32 v[198:199], v[152:153], v[28:29], v[198:199]
    v_pk_fma_f32 v[200:201], v[128:129], v[28:29], v[200:201] neg_lo:[1,0,0] neg_hi:[1,0,0]
    v_cvt_pk_bf16_f32 v102, v194, v196
    v_cvt_pk_bf16_f32 v103, v195, v197
    v_cvt_pk_bf16_f32 v104, v198, v200
    v_cvt_pk_bf16_f32 v105, v199, v201
    v_mfma_f32_16x16x32_bf16 v[106:109], a[32:35], v[82:85], 0
    v_mfma_f32_16x16x32_bf16 v[130:133], a[36:39], v[82:85], 0
    v_mfma_f32_16x16x32_bf16 v[110:113], a[32:35], v[86:89], 0
    v_mfma_f32_16x16x32_bf16 v[134:137], a[36:39], v[86:89], 0
    v_mfma_f32_16x16x32_bf16 v[114:117], a[32:35], v[90:93], 0
    v_mfma_f32_16x16x32_bf16 v[138:141], a[36:39], v[90:93], 0
    v_mfma_f32_16x16x32_bf16 v[118:121], a[32:35], v[94:97], 0
    v_mfma_f32_16x16x32_bf16 v[142:145], a[36:39], v[94:97], 0
    v_mfma_f32_16x16x32_bf16 v[122:125], a[32:35], v[98:101], 0
    v_mfma_f32_16x16x32_bf16 v[146:149], a[36:39], v[98:101], 0
    v_mfma_f32_16x16x32_bf16 v[126:129], a[32:35], v[102:105], 0
    v_mfma_f32_16x16x32_bf16 v[150:153], a[36:39], v[102:105], 0
    v_pk_mul_f32 v[194:195], v[38:39], v[106:107]
    v_pk_mul_f32 v[196:197], v[38:39], v[130:131]
    v_pk_mul_f32 v[198:199], v[154:155], v[110:111]
    v_pk_mul_f32 v[200:201], v[154:155], v[134:135]
    v_pk_fma_f32 v[194:195], v[42:43], v[130:131], v[194:195] neg_lo:[1,0,0] neg_hi:[1,0,0]
    v_pk_fma_f32 v[196:197], v[42:43], v[106:107], v[196:197]
    v_pk_fma_f32 v[198:199], v[158:159], v[134:135], v[198:199] neg_lo:[1,0,0] neg_hi:[1,0,0]
    v_pk_fma_f32 v[200:201], v[158:159], v[110:111], v[200:201]
    v_pk_fma_f32 v[194:195], v[166:167], v[126:127], v[194:195] neg_lo:[1,0,0] neg_hi:[1,0,0]
    v_pk_fma_f32 v[196:197], v[162:163], v[126:127], v[196:197]
    v_pk_fma_f32 v[198:199], v[66:67], v[146:147], v[198:199]
    v_pk_fma_f32 v[200:201], v[66:67], v[122:123], v[200:201] neg_lo:[1,0,0] neg_hi:[1,0,0]
    v_pk_fma_f32 v[194:195], v[162:163], v[150:151], v[194:195] neg_lo:[1,0,0] neg_hi:[1,0,0]
    v_pk_fma_f32 v[196:197], v[166:167], v[150:151], v[196:197] neg_lo:[1,0,0] neg_hi:[1,0,0]
    v_pk_fma_f32 v[198:199], v[70:71], v[122:123], v[198:199]
    v_pk_fma_f32 v[200:201], v[70:71], v[146:147], v[200:201]
    v_cvt_pk_bf16_f32 v82, v196, v194
    v_cvt_pk_bf16_f32 v86, v200, v198
    v_cvt_pk_bf16_f32 v83, v197, v195
    v_cvt_pk_bf16_f32 v87, v201, v199
    v_pk_mul_f32 v[194:195], v[40:41], v[108:109]
    v_pk_mul_f32 v[196:197], v[40:41], v[132:133]
    v_pk_mul_f32 v[198:199], v[156:157], v[112:113]
    v_pk_mul_f32 v[200:201], v[156:157], v[136:137]
    v_pk_fma_f32 v[194:195], v[44:45], v[132:133], v[194:195] neg_lo:[1,0,0] neg_hi:[1,0,0]
    v_pk_fma_f32 v[196:197], v[44:45], v[108:109], v[196:197]
    v_pk_fma_f32 v[198:199], v[160:161], v[136:137], v[198:199] neg_lo:[1,0,0] neg_hi:[1,0,0]
    v_pk_fma_f32 v[200:201], v[160:161], v[112:113], v[200:201]
    v_pk_fma_f32 v[194:195], v[168:169], v[128:129], v[194:195] neg_lo:[1,0,0] neg_hi:[1,0,0]
    v_pk_fma_f32 v[196:197], v[164:165], v[128:129], v[196:197]
    v_pk_fma_f32 v[198:199], v[68:69], v[148:149], v[198:199]
    v_pk_fma_f32 v[200:201], v[68:69], v[124:125], v[200:201] neg_lo:[1,0,0] neg_hi:[1,0,0]
    v_pk_fma_f32 v[194:195], v[164:165], v[152:153], v[194:195] neg_lo:[1,0,0] neg_hi:[1,0,0]
    v_pk_fma_f32 v[196:197], v[168:169], v[152:153], v[196:197] neg_lo:[1,0,0] neg_hi:[1,0,0]
    v_pk_fma_f32 v[198:199], v[72:73], v[124:125], v[198:199]
    v_pk_fma_f32 v[200:201], v[72:73], v[148:149], v[200:201]
    v_cvt_pk_bf16_f32 v84, v196, v194
    v_cvt_pk_bf16_f32 v88, v200, v198
    v_cvt_pk_bf16_f32 v85, v197, v195
    v_cvt_pk_bf16_f32 v89, v201, v199
    s_branch Ljm3
Lre5:
    s_movk_i32 s37, 4000
Llp6:
    s_sleep 4
    buffer_load_dwordx4 v[82:85], v2, s[48:51], s12 offen offset:0 sc1
    buffer_load_dwordx4 v[86:89], v2, s[48:51], s12 offen offset:1024 sc1
    buffer_load_dwordx4 v[90:93], v2, s[48:51], s12 offen offset:2048 sc1
    buffer_load_dwordx4 v[94:97], v2, s[48:51], s12 offen offset:3072 sc1
    s_waitcnt vmcnt(0)
    v_bitop3_b32 v5, v83, v85, s58 bitop3:0x7e
    v_bitop3_b32 v8, v87, v89, s58 bitop3:0x7e
    v_or_b32 v5, v8, v5
    v_bitop3_b32 v8, v91, v93, s58 bitop3:0x7e
    v_or_b32 v5, v8, v5
    v_bitop3_b32 v8, v95, v97, s58 bitop3:0x7e
    v_or_b32 v5, v8, v5
    v_cmp_ne_u32 vcc, 0, v5
    s_cbranch_vccz Lok4
    s_sub_u32 s37, s37, 1
    s_cmp_lg_u32 s37, 0
    s_cbranch_scc1 Llp6
    s_branch Lok4
Lre10:
    s_movk_i32 s37, 4000
Llp11:
    s_sleep 6
    s_mov_b64 s[14:15], 0
    v_xor_b32 v5, s60, v50
    v_bitop3_b32 v5, v51, s61, v5 bitop3:0xbe
    v_bitop3_b32 v5, v52, s62, v5 bitop3:0xbe
    v_bitop3_b32 v5, v53, s63, v5 bitop3:0xbe
    v_and_b32 v5, 0x10001, v5
    s_nop 1
    v_or_b32_dpp v5, v5, v5 quad_perm:[1,0,3,2] row_mask:0xf bank_mask:0xf
    s_nop 1
    v_or_b32_dpp v5, v5, v5 quad_perm:[2,3,0,1] row_mask:0xf bank_mask:0xf
    v_cmp_ne_u32 vcc, 0, v5
    s_nop 1
    s_or_b64 s[14:15], s[14:15], vcc
    s_cbranch_vccz Lsk12
    s_mov_b64 exec, vcc
    buffer_load_dwordx4 v[50:53], v2, s[48:51], s56 offen offset:0 sc1
    s_mov_b64 exec, -1
Lsk12:
    v_xor_b32 v5, s60, v54
    v_bitop3_b32 v5, v55, s61, v5 bitop3:0xbe
    v_bitop3_b32 v5, v56, s62, v5 bitop3:0xbe
    v_bitop3_b32 v5, v57, s63, v5 bitop3:0xbe
    v_and_b32 v5, 0x10001, v5
    s_nop 1
    v_or_b32_dpp v5, v5, v5 quad_perm:[1,0,3,2] row_mask:0xf bank_mask:0xf
    s_nop 1
    v_or_b32_dpp v5, v5, v5 quad_perm:[2,3,0,1] row_mask:0xf bank_mask:0xf
    v_cmp_ne_u32 vcc, 0, v5
    s_nop 1
    s_or_b64 s[14:15], s[14:15], vcc
    s_cbranch_vccz Lsk13
    s_mov_b64 exec, vcc
    buffer_load_dwordx4 v[54:57], v2, s[48:51], s56 offen offset:1024 sc1
    s_mov_b64 exec, -1
Lsk13:
    v_xor_b32 v5, s60, v58
    v_bitop3_b32 v5, v59, s61, v5 bitop3:0xbe
    v_bitop3_b32 v5, v60, s62, v5 bitop3:0xbe
    v_bitop3_b32 v5, v61, s63, v5 bitop3:0xbe
    v_and_b32 v5, 0x10001, v5
    s_nop 1
    v_or_b32_dpp v5, v5, v5 quad_perm:[1,0,3,2] row_mask:0xf bank_mask:0xf
    s_nop 1
    v_or_b32_dpp v5, v5, v5 quad_perm:[2,3,0,1] row_mask:0xf bank_mask:0xf
    v_cmp_ne_u32 vcc, 0, v5
    s_nop 1
    s_or_b64 s[14:15], s[14:15], vcc
    s_cbranch_vccz Lsk14
    s_mov_b64 exec, vcc
    buffer_load_dwordx4 v[58:61], v2, s[48:51], s56 offen offset:2048 sc1
    s_mov_b64 exec, -1
Lsk14:
    v_xor_b32 v5, s60, v62
    v_bitop3_b32 v5, v63, s61, v5 bitop3:0xbe
    v_bitop3_b32 v5, v64, s62, v5 bitop3:0xbe
    v_bitop3_b32 v5, v65, s63, v5 bitop3:0xbe
    v_and_b32 v5, 0x10001, v5
    s_nop 1
    v_or_b32_dpp v5, v5, v5 quad_perm:[1,0,3,2] row_mask:0xf bank_mask:0xf
    s_nop 1
    v_or_b32_dpp v5, v5, v5 quad_perm:[2,3,0,1] row_mask:0xf bank_mask:0xf
    v_cmp_ne_u32 vcc, 0, v5
    s_nop 1
    s_or_b64 s[14:15], s[14:15], vcc
    s_cbranch_vccz Lsk15
    s_mov_b64 exec, vcc
    buffer_load_dwordx4 v[62:65], v2, s[48:51], s56 offen offset:3072 sc1
    s_mov_b64 exec, -1
Lsk15:
    s_cmp_eq_u64 s[14:15], 0
    s_cbranch_scc1 Lok9
    s_waitcnt vmcnt(0)
    s_sub_u32 s37, s37, 1
    s_cmp_lg_u32 s37, 0
    s_cbranch_scc1 Llp11
    s_branch Lok9
Lre17:
    s_movk_i32 s37, 4000
Llp18:
    s_sleep 4
    buffer_load_dwordx4 v[122:125], v9, s[48:51], s12 offen offset:0 sc1
    buffer_load_dwordx4 v[126:129], v9, s[48:51], s12 offen offset:1024 sc1
    buffer_load_dwordx4 v[146:149], v9, s[48:51], s12 offen offset:2048 sc1
    buffer_load_dwordx4 v[150:153], v9, s[48:51], s12 offen offset:3072 sc1
    s_waitcnt vmcnt(0)
    v_bitop3_b32 v5, v123, v125, s58 bitop3:0x7e
    v_bitop3_b32 v8, v127, v129, s58 bitop3:0x7e
    v_or_b32 v5, v8, v5
    v_bitop3_b32 v8, v147, v149, s58 bitop3:0x7e
    v_or_b32 v5, v8, v5
    v_bitop3_b32 v8, v151, v153, s58 bitop3:0x7e
    v_or_b32 v5, v8, v5
    v_cmp_ne_u32 vcc, 0, v5
    s_cbranch_vccz Lok16
    s_sub_u32 s37, s37, 1
    s_cmp_lg_u32 s37, 0
    s_cbranch_scc1 Llp18
    s_branch Lok16
Lre21:
    s_movk_i32 s37, 4000
Llp22:
    s_sleep 6
    s_mov_b64 s[12:13], 0
    v_xor_b32 v5, s60, v50
    v_bitop3_b32 v5, v51, s61, v5 bitop3:0xbe
    v_bitop3_b32 v5, v52, s62, v5 bitop3:0xbe
    v_bitop3_b32 v5, v53, s63, v5 bitop3:0xbe
    v_and_b32 v5, 0x10001, v5
    s_nop 1
    v_or_b32_dpp v5, v5, v5 quad_perm:[1,0,3,2] row_mask:0xf bank_mask:0xf
    s_nop 1
    v_or_b32_dpp v5, v5, v5 quad_perm:[2,3,0,1] row_mask:0xf bank_mask:0xf
    v_cmp_ne_u32 vcc, 0, v5
    s_nop 1
    s_or_b64 s[12:13], s[12:13], vcc
    s_cbranch_vccz Lsk23
    s_mov_b64 exec, vcc
    buffer_load_dwordx4 v[50:53], v2, s[48:51], s56 offen offset:0 sc1
    s_mov_b64 exec, -1
Lsk23:
    v_xor_b32 v5, s60, v54
    v_bitop3_b32 v5, v55, s61, v5 bitop3:0xbe
    v_bitop3_b32 v5, v56, s62, v5 bitop3:0xbe
    v_bitop3_b32 v5, v57, s63, v5 bitop3:0xbe
    v_and_b32 v5, 0x10001, v5
    s_nop 1
    v_or_b32_dpp v5, v5, v5 quad_perm:[1,0,3,2] row_mask:0xf bank_mask:0xf
    s_nop 1
    v_or_b32_dpp v5, v5, v5 quad_perm:[2,3,0,1] row_mask:0xf bank_mask:0xf
    v_cmp_ne_u32 vcc, 0, v5
    s_nop 1
    s_or_b64 s[12:13], s[12:13], vcc
    s_cbranch_vccz Lsk24
    s_mov_b64 exec, vcc
    buffer_load_dwordx4 v[54:57], v2, s[48:51], s56 offen offset:1024 sc1
    s_mov_b64 exec, -1
Lsk24:
    v_xor_b32 v5, s60, v58
    v_bitop3_b32 v5, v59, s61, v5 bitop3:0xbe
    v_bitop3_b32 v5, v60, s62, v5 bitop3:0xbe
    v_bitop3_b32 v5, v61, s63, v5 bitop3:0xbe
    v_and_b32 v5, 0x10001, v5
    s_nop 1
    v_or_b32_dpp v5, v5, v5 quad_perm:[1,0,3,2] row_mask:0xf bank_mask:0xf
    s_nop 1
    v_or_b32_dpp v5, v5, v5 quad_perm:[2,3,0,1] row_mask:0xf bank_mask:0xf
    v_cmp_ne_u32 vcc, 0, v5
    s_nop 1
    s_or_b64 s[12:13], s[12:13], vcc
    s_cbranch_vccz Lsk25
    s_mov_b64 exec, vcc
    buffer_load_dwordx4 v[58:61], v2, s[48:51], s56 offen offset:2048 sc1
    s_mov_b64 exec, -1
Lsk25:
    v_xor_b32 v5, s60, v62
    v_bitop3_b32 v5, v63, s61, v5 bitop3:0xbe
    v_bitop3_b32 v5, v64, s62, v5 bitop3:0xbe
    v_bitop3_b32 v5, v65, s63, v5 bitop3:0xbe
    v_and_b32 v5, 0x10001, v5
    s_nop 1
    v_or_b32_dpp v5, v5, v5 quad_perm:[1,0,3,2] row_mask:0xf bank_mask:0xf
    s_nop 1
    v_or_b32_dpp v5, v5, v5 quad_perm:[2,3,0,1] row_mask:0xf bank_mask:0xf
    v_cmp_ne_u32 vcc, 0, v5
    s_nop 1
    s_or_b64 s[12:13], s[12:13], vcc
    s_cbranch_vccz Lsk26
    s_mov_b64 exec, vcc
    buffer_load_dwordx4 v[62:65], v2, s[48:51], s56 offen offset:3072 sc1
    s_mov_b64 exec, -1
Lsk26:
    s_cmp_eq_u64 s[12:13], 0
    s_cbranch_scc1 Lok20
    s_waitcnt vmcnt(0)
    s_sub_u32 s37, s37, 1
    s_cmp_lg_u32 s37, 0
    s_cbranch_scc1 Llp22
    s_branch Lok20
Lre28:
    s_movk_i32 s37, 4000
Llp29:
    s_sleep 6
    s_mov_b64 s[12:13], 0
    v_xor_b32 v8, s60, v50
    v_bitop3_b32 v8, v51, s61, v8 bitop3:0xbe
    v_bitop3_b32 v8, v52, s62, v8 bitop3:0xbe
    v_bitop3_b32 v8, v53, s63, v8 bitop3:0xbe
    v_and_b32 v8, 0x10001, v8
    s_nop 1
    v_or_b32_dpp v8, v8, v8 quad_perm:[1,0,3,2] row_mask:0xf bank_mask:0xf
    s_nop 1
    v_or_b32_dpp v8, v8, v8 quad_perm:[2,3,0,1] row_mask:0xf bank_mask:0xf
    v_cmp_ne_u32 vcc, 0, v8
    s_nop 1
    s_or_b64 s[12:13], s[12:13], vcc
    s_cbranch_vccz Lsk30
    s_mov_b64 exec, vcc
    buffer_load_dwordx4 v[50:53], v6, s[48:51], s4 offen sc1
    s_mov_b64 exec, -1
Lsk30:
    v_xor_b32 v8, s60, v54
    v_bitop3_b32 v8, v55, s61, v8 bitop3:0xbe
    v_bitop3_b32 v8, v56, s62, v8 bitop3:0xbe
    v_bitop3_b32 v8, v57, s63, v8 bitop3:0xbe
    v_and_b32 v8, 0x10001, v8
    s_nop 1
    v_or_b32_dpp v8, v8, v8 quad_perm:[1,0,3,2] row_mask:0xf bank_mask:0xf
    s_nop 1
    v_or_b32_dpp v8, v8, v8 quad_perm:[2,3,0,1] row_mask:0xf bank_mask:0xf
    v_cmp_ne_u32 vcc, 0, v8
    s_nop 1
    s_or_b64 s[12:13], s[12:13], vcc
    s_cbranch_vccz Lsk31
    s_mov_b64 exec, vcc
    buffer_load_dwordx4 v[54:57], v6, s[48:51], s5 offen sc1
    s_mov_b64 exec, -1
Lsk31:
    v_xor_b32 v8, s60, v58
    v_bitop3_b32 v8, v59, s61, v8 bitop3:0xbe
    v_bitop3_b32 v8, v60, s62, v8 bitop3:0xbe
    v_bitop3_b32 v8, v61, s63, v8 bitop3:0xbe
    v_and_b32 v8, 0x10001, v8
    s_nop 1
    v_or_b32_dpp v8, v8, v8 quad_perm:[1,0,3,2] row_mask:0xf bank_mask:0xf
    s_nop 1
    v_or_b32_dpp v8, v8, v8 quad_perm:[2,3,0,1] row_mask:0xf bank_mask:0xf
    v_cmp_ne_u32 vcc, 0, v8
    s_nop 1
    s_or_b64 s[12:13], s[12:13], vcc
    s_cbranch_vccz Lsk32
    s_mov_b64 exec, vcc
    buffer_load_dwordx4 v[58:61], v6, s[48:51], s6 offen sc1
    s_mov_b64 exec, -1
Lsk32:
    v_xor_b32 v8, s60, v62
    v_bitop3_b32 v8, v63, s61, v8 bitop3:0xbe
    v_bitop3_b32 v8, v64, s62, v8 bitop3:0xbe
    v_bitop3_b32 v8, v65, s63, v8 bitop3:0xbe
    v_and_b32 v8, 0x10001, v8
    s_nop 1
    v_or_b32_dpp v8, v8, v8 quad_perm:[1,0,3,2] row_mask:0xf bank_mask:0xf
    s_nop 1
    v_or_b32_dpp v8, v8, v8 quad_perm:[2,3,0,1] row_mask:0xf bank_mask:0xf
    v_cmp_ne_u32 vcc, 0, v8
    s_nop 1
    s_or_b64 s[12:13], s[12:13], vcc
    s_cbranch_vccz Lsk33
    s_mov_b64 exec, vcc
    buffer_load_dwordx4 v[62:65], v6, s[48:51], s7 offen sc1
    s_mov_b64 exec, -1
Lsk33:
    s_cmp_eq_u64 s[12:13], 0
    s_cbranch_scc1 Lok27
    s_waitcnt vmcnt(0)
    s_sub_u32 s37, s37, 1
    s_cmp_lg_u32 s37, 0
    s_cbranch_scc1 Llp29
    s_branch Lok27
Lre35:
    s_movk_i32 s37, 4000
Llp36:
    s_sleep 6
    s_mov_b64 s[16:17], 0
    v_xor_b32 v8, s52, v82
    v_bitop3_b32 v8, v83, s53, v8 bitop3:0xbe
    v_bitop3_b32 v8, v84, s54, v8 bitop3:0xbe
    v_bitop3_b32 v8, v85, s55, v8 bitop3:0xbe
    v_and_b32 v8, 0x10001, v8
    s_nop 1
    v_or_b32_dpp v8, v8, v8 quad_perm:[1,0,3,2] row_mask:0xf bank_mask:0xf
    s_nop 1
    v_or_b32_dpp v8, v8, v8 quad_perm:[2,3,0,1] row_mask:0xf bank_mask:0xf
    v_cmp_ne_u32 vcc, 0, v8
    s_nop 1
    s_or_b64 s[16:17], s[16:17], vcc
    s_cbranch_vccz Lsk37
    s_mov_b64 exec, vcc
    buffer_load_dwordx4 v[82:85], v27, s[48:51], s12 offen sc1
    s_mov_b64 exec, -1
Lsk37:
    v_xor_b32 v8, s52, v86
    v_bitop3_b32 v8, v87, s53, v8 bitop3:0xbe
    v_bitop3_b32 v8, v88, s54, v8 bitop3:0xbe
    v_bitop3_b32 v8, v89, s55, v8 bitop3:0xbe
    v_and_b32 v8, 0x10001, v8
    s_nop 1
    v_or_b32_dpp v8, v8, v8 quad_perm:[1,0,3,2] row_mask:0xf bank_mask:0xf
    s_nop 1
    v_or_b32_dpp v8, v8, v8 quad_perm:[2,3,0,1] row_mask:0xf bank_mask:0xf
    v_cmp_ne_u32 vcc, 0, v8
    s_nop 1
    s_or_b64 s[16:17], s[16:17], vcc
    s_cbranch_vccz Lsk38
    s_mov_b64 exec, vcc
    buffer_load_dwordx4 v[86:89], v27, s[48:51], s13 offen sc1
    s_mov_b64 exec, -1
Lsk38:
    s_cmp_eq_u64 s[16:17], 0
    s_cbranch_scc1 Lok34
    s_waitcnt vmcnt(0)
    s_sub_u32 s37, s37, 1
    s_cmp_lg_u32 s37, 0
    s_cbranch_scc1 Llp36
    s_branch Lok34
Lepo40:
    s_add_u32 s36, s41, 1
    v_mov_b32 v46, s36
    s_lshl_b32 s36, s46, 7
    s_add_u32 s36, s36, 256
    v_mov_b32 v47, s36
    s_mov_b64 exec, 1
    global_store_dword v47, v46, s[42:43]
    s_mov_b64 exec, -1
    s_branch Lep39
Lre42:
    s_movk_i32 s37, 4000
Llp43:
    s_sleep 6
    s_mov_b64 s[16:17], 0
    v_xor_b32 v8, s52, v90
    v_bitop3_b32 v8, v91, s53, v8 bitop3:0xbe
    v_bitop3_b32 v8, v92, s54, v8 bitop3:0xbe
    v_bitop3_b32 v8, v93, s55, v8 bitop3:0xbe
    v_and_b32 v8, 0x10001, v8
    s_nop 1
    v_or_b32_dpp v8, v8, v8 quad_perm:[1,0,3,2] row_mask:0xf bank_mask:0xf
    s_nop 1
    v_or_b32_dpp v8, v8, v8 quad_perm:[2,3,0,1] row_mask:0xf bank_mask:0xf
    v_cmp_ne_u32 vcc, 0, v8
    s_nop 1
    s_or_b64 s[16:17], s[16:17], vcc
    s_cbranch_vccz Lsk44
    s_mov_b64 exec, vcc
    buffer_load_dwordx4 v[90:93], v27, s[48:51], s14 offen sc1
    s_mov_b64 exec, -1
Lsk44:
    v_xor_b32 v8, s52, v94
    v_bitop3_b32 v8, v95, s53, v8 bitop3:0xbe
    v_bitop3_b32 v8, v96, s54, v8 bitop3:0xbe
    v_bitop3_b32 v8, v97, s55, v8 bitop3:0xbe
    v_and_b32 v8, 0x10001, v8
    s_nop 1
    v_or_b32_dpp v8, v8, v8 quad_perm:[1,0,3,2] row_mask:0xf bank_mask:0xf
    s_nop 1
    v_or_b32_dpp v8, v8, v8 quad_perm:[2,3,0,1] row_mask:0xf bank_mask:0xf
    v_cmp_ne_u32 vcc, 0, v8
    s_nop 1
    s_or_b64 s[16:17], s[16:17], vcc
    s_cbranch_vccz Lsk45
    s_mov_b64 exec, vcc
    buffer_load_dwordx4 v[94:97], v27, s[48:51], s15 offen sc1
    s_mov_b64 exec, -1
Lsk45:
    s_cmp_eq_u64 s[16:17], 0
    s_cbranch_scc1 Lok41
    s_waitcnt vmcnt(0)
    s_sub_u32 s37, s37, 1
    s_cmp_lg_u32 s37, 0
    s_cbranch_scc1 Llp43
    s_branch Lok41
Lre47:
    s_movk_i32 s37, 4000
Llp48:
    s_sleep 6
    s_mov_b64 s[10:11], 0
    v_xor_b32 v3, s4, v116
    v_bitop3_b32 v3, v117, s5, v3 bitop3:0xbe
    v_bitop3_b32 v3, v118, s6, v3 bitop3:0xbe
    v_bitop3_b32 v3, v119, s7, v3 bitop3:0xbe
    v_and_b32 v3, 0x10001, v3
    s_nop 1
    v_or_b32_dpp v3, v3, v3 quad_perm:[1,0,3,2] row_mask:0xf bank_mask:0xf
    s_nop 1
    v_or_b32_dpp v3, v3, v3 quad_perm:[2,3,0,1] row_mask:0xf bank_mask:0xf
    v_cmp_ne_u32 vcc, 0, v3
    s_nop 1
    s_or_b64 s[10:11], s[10:11], vcc
    s_cbranch_vccz Lsk49
    s_mov_b64 exec, vcc
    buffer_load_dwordx4 v[116:119], v2, s[52:55], s50 offen offset:0 sc1
    s_mov_b64 exec, -1
Lsk49:
    v_xor_b32 v3, s4, v120
    v_bitop3_b32 v3, v121, s5, v3 bitop3:0xbe
    v_bitop3_b32 v3, v122, s6, v3 bitop3:0xbe
    v_bitop3_b32 v3, v123, s7, v3 bitop3:0xbe
    v_and_b32 v3, 0x10001, v3
    s_nop 1
    v_or_b32_dpp v3, v3, v3 quad_perm:[1,0,3,2] row_mask:0xf bank_mask:0xf
    s_nop 1
    v_or_b32_dpp v3, v3, v3 quad_perm:[2,3,0,1] row_mask:0xf bank_mask:0xf
    v_cmp_ne_u32 vcc, 0, v3
    s_nop 1
    s_or_b64 s[10:11], s[10:11], vcc
    s_cbranch_vccz Lsk50
    s_mov_b64 exec, vcc
    buffer_load_dwordx4 v[120:123], v2, s[52:55], s50 offen offset:1024 sc1
    s_mov_b64 exec, -1
Lsk50:
    v_xor_b32 v3, s4, v124
    v_bitop3_b32 v3, v125, s5, v3 bitop3:0xbe
    v_bitop3_b32 v3, v126, s6, v3 bitop3:0xbe
    v_bitop3_b32 v3, v127, s7, v3 bitop3:0xbe
    v_and_b32 v3, 0x10001, v3
    s_nop 1
    v_or_b32_dpp v3, v3, v3 quad_perm:[1,0,3,2] row_mask:0xf bank_mask:0xf
    s_nop 1
    v_or_b32_dpp v3, v3, v3 quad_perm:[2,3,0,1] row_mask:0xf bank_mask:0xf
    v_cmp_ne_u32 vcc, 0, v3
    s_nop 1
    s_or_b64 s[10:11], s[10:11], vcc
    s_cbranch_vccz Lsk51
    s_mov_b64 exec, vcc
    buffer_load_dwordx4 v[124:127], v2, s[52:55], s50 offen offset:2048 sc1
    s_mov_b64 exec, -1
Lsk51:
    v_xor_b32 v3, s4, v128
    v_bitop3_b32 v3, v129, s5, v3 bitop3:0xbe
    v_bitop3_b32 v3, v130, s6, v3 bitop3:0xbe
    v_bitop3_b32 v3, v131, s7, v3 bitop3:0xbe
    v_and_b32 v3, 0x10001, v3
    s_nop 1
    v_or_b32_dpp v3, v3, v3 quad_perm:[1,0,3,2] row_mask:0xf bank_mask:0xf
    s_nop 1
    v_or_b32_dpp v3, v3, v3 quad_perm:[2,3,0,1] row_mask:0xf bank_mask:0xf
    v_cmp_ne_u32 vcc, 0, v3
    s_nop 1
    s_or_b64 s[10:11], s[10:11], vcc
    s_cbranch_vccz Lsk52
    s_mov_b64 exec, vcc
    buffer_load_dwordx4 v[128:131], v2, s[52:55], s50 offen offset:3072 sc1
    s_mov_b64 exec, -1
Lsk52:
    s_cmp_eq_u64 s[10:11], 0
    s_cbranch_scc1 Lok46
    s_waitcnt vmcnt(0)
    s_sub_u32 s37, s37, 1
    s_cmp_lg_u32 s37, 0
    s_cbranch_scc1 Llp48
    s_branch Lok46
L_codeend:
.section .rodata,"a"
.p2align 6
.amdhsa_kernel concat_heads__spectral_gfnet__ssm_conv_s4__prompt_kernel
  .amdhsa_next_free_vgpr 256
  .amdhsa_next_free_sgpr 102
  .amdhsa_accum_offset 208
  .amdhsa_group_segment_fixed_size 0
  .amdhsa_kernarg_size 120
  .amdhsa_user_sgpr_count 2
  .amdhsa_user_sgpr_kernarg_segment_ptr 1
  .amdhsa_system_sgpr_workgroup_id_x 1
  .amdhsa_float_denorm_mode_32 3
.end_amdhsa_kernel
```
